```python
import torch

def _softmax(x, axis=-1):
    return torch.softmax(x, dim=axis)

def _gelu(x):
    return torch.nn.functional.gelu(x, approximate='tanh')

def _silu(x):
    return torch.nn.functional.silu(x)

def _sigmoid(x):
    return torch.sigmoid(x)

def _layernorm(x, axis=-1, eps=1e-05):
    m = x.mean(dim=axis, keepdim=True)
    v = x.var(dim=axis, keepdim=True, unbiased=False)
    return (x - m) / torch.sqrt(v + eps)

def _scatter_add(tgt, idx, src, axis=0):
    return tgt.clone().index_add_(axis, idx, src)

def _segment_sum(src, seg, n):
    out = torch.zeros((n,) + src.shape[1:], dtype=src.dtype)
    return out.index_add_(0, seg, src)

def _pad(x, pw):
    flat = tuple((v for pair in reversed(pw) for v in pair))
    return torch.nn.functional.pad(x, flat)
kernel_name = 'adaLN_cond__sliding_block_cached__geglu_ffn__decode'

def setup_inputs():

    _w = lambda a: (lambda t: t.to(torch.bfloat16) if t.is_floating_point() else t)(torch.as_tensor(a))

    def _A_setup():
        B, Sq, D = (1, 1, 448)
        Hq, Hkv, Sk, Dh = (16, 8, 32768, 256)
        assert Hq % Hkv == 0, (Hq, Hkv)
        return {'x': _w((lambda *s: torch.randn(*s, dtype=torch.bfloat16) * 0.05)(B, Sq, D)), 'k_cache': _w((lambda *s: torch.randn(*s, dtype=torch.bfloat16) * 3.2)(B, Hkv, Sk, Dh)), 'v_cache': _w((lambda *s: torch.randn(*s, dtype=torch.bfloat16) * 0.4)(B, Hkv, Sk, Dh)), 'wq': _w((lambda *s: torch.randn(*s, dtype=torch.bfloat16) * 3.2)(D, Hq * Dh) * D ** (-0.5)), 'wo': _w((lambda *s: torch.randn(*s, dtype=torch.bfloat16) * 0.4)(Hq * Dh, D) * (Hq * Dh) ** (-0.5))}
    _A_in = _A_setup()

    def _B_setup():
        B, S, D, F = (1, 1, 448, 1792)
        return {'x': _w((lambda *s: torch.randn(*s, dtype=torch.bfloat16) * 0.05)(B, S, D)), 'w_gate': _w((lambda *s: torch.randn(*s, dtype=torch.bfloat16) * 0.05)(D, F)), 'w_up': _w((lambda *s: torch.randn(*s, dtype=torch.bfloat16) * 0.05)(D, F)), 'w_down': _w((lambda *s: torch.randn(*s, dtype=torch.bfloat16) * 0.05)(F, D))}
    _B_in = _B_setup()
    return {'A_x': _A_in['x'], 'A_k_cache': _A_in['k_cache'], 'A_v_cache': _A_in['v_cache'], 'A_wq': _A_in['wq'], 'A_wo': _A_in['wo'], 'B_x': _B_in['x'], 'B_w_gate': _B_in['w_gate'], 'B_w_up': _B_in['w_up'], 'B_w_down': _B_in['w_down'], 'c': _w((lambda *s: torch.randn(*s, dtype=torch.bfloat16) * 0.1)(1, 448) * 8.0), 'w_mod': _w((lambda *s: torch.randn(*s, dtype=torch.bfloat16) * 0.1)(448, 6 * 448) * 448 ** (-0.5) * 8.0)}

def reference(A_x, A_k_cache, A_v_cache, A_wq, A_wo, B_x, B_w_gate, B_w_up, B_w_down, c, w_mod):

    def _A_ref(x, k_cache, v_cache, wq, wo):
        B, Sq, D = x.shape
        Hq, Dh = (16, 256)
        Hkv, Sk = (k_cache.shape[1], k_cache.shape[2])
        W = min(4096, max(256, Sk // 4))
        rep = Hq // Hkv
        q = (lambda x, *d: x.permute(*d))((x @ wq).reshape(B, Sq, Hq, Dh), 0, 2, 1, 3)
        k = (lambda x, n, axis: torch.repeat_interleave(x, n, dim=axis))(k_cache[:, :, Sk - W:, :], rep, axis=1)
        v = (lambda x, n, axis: torch.repeat_interleave(x, n, dim=axis))(v_cache[:, :, Sk - W:, :], rep, axis=1)
        scores = torch.einsum('bhqd,bhkd->bhqk', q, k) * Dh ** (-0.5)
        p = _softmax(scores, axis=-1)
        o = torch.einsum('bhqk,bhkd->bhqd', p, v)
        return (lambda x, *d: x.permute(*d))(o, 0, 2, 1, 3).reshape(B, Sq, Hq * Dh) @ wo

    def _B_ref(x, w_gate, w_up, w_down):
        return _gelu(x @ w_gate) * (x @ w_up) @ w_down
    x = A_x
    mod = (_silu(c) @ w_mod).reshape(c.shape[0], 6, 1, -1)
    sa, ca, ga, sb, cb, gb = (mod[:, 0].clone(), mod[:, 1].clone(), mod[:, 2].clone(), mod[:, 3].clone(), mod[:, 4].clone(), mod[:, 5].clone())
    h = _layernorm(x, axis=-1) * (1 + ca) + sa
    x = x + ga * _A_ref(h, A_k_cache, A_v_cache, A_wq, A_wo)
    h = _layernorm(x, axis=-1) * (1 + cb) + sb
    x = x + gb * _B_ref(h, B_w_gate, B_w_up, B_w_down)
    return x
```

```asm
; @launch grid=(256,1,1) block=(1024,1,1) lds=26624
.amdgcn_target "amdgcn-amd-amdhsa--gfx950"
.text
.globl adaLN_cond__sliding_block_cached__geglu_ffn__decode_kernel
.p2align 12
.p2align 8
.type adaLN_cond__sliding_block_cached__geglu_ffn__decode_kernel,@function
adaLN_cond__sliding_block_cached__geglu_ffn__decode_kernel:
  s_cmp_ge_u32 s2, 256
  s_cbranch_scc1 L_exit
  s_load_dwordx16 s[4:19], s[0:1], 0
  s_load_dwordx8 s[20:27], s[0:1], 64
  s_load_dwordx4 s[28:31], s[0:1], 96
  v_lshrrev_b32 v1, 6, v0
  v_and_b32 v0, 63, v0
  v_readfirstlane_b32 s3, v1
  s_and_b32 s53, s2, 7
  s_lshr_b32 s54, s2, 3
  s_cmp_lg_u32 s3, 15
  s_cbranch_scc1 L_nopf
  s_cmp_ge_u32 s54, (L_codeend-adaLN_cond__sliding_block_cached__geglu_ffn__decode_kernel)/1024
  s_cbranch_scc1 L_nopf
  s_getpc_b64 s[56:57]
L_pc:
  s_lshl_b32 s55, s54, 10
  s_sub_u32 s56, s56, L_pc-adaLN_cond__sliding_block_cached__geglu_ffn__decode_kernel
  s_subb_u32 s57, s57, 0
  v_lshl_add_u32 v3, v0, 4, s55
  global_load_dwordx4 v[124:127], v3, s[56:57]
L_nopf:
  v_and_b32 v1, 15, v0
  v_lshrrev_b32 v2, 4, v0

  s_cmp_lt_u32 s54, 8
  s_cbranch_scc1 L_service
  s_sub_u32 s54, s54, 8
  s_cmp_ge_u32 s54, 22
  s_cbranch_scc1 L_service2

  s_cmp_ge_u32 s3, 12
  s_cbranch_scc1 L_attw

  s_mul_i32 s57, s54, 98304
  s_lshl_b32 s56, s3, 13
  s_add_u32 s57, s57, s56
  s_min_u32 s56, s54, 6
  s_lshl_b32 s56, s56, 13
  s_add_u32 s56, s56, 8192
  s_sub_u32 s57, s57, s56

  s_cmp_ge_u32 s54, 7
  s_cbranch_scc1 L_att1
  s_cmp_eq_u32 s3, 0
  s_cbranch_scc1 L_p0
  s_cmp_lt_u32 s3, 1
  s_cselect_b32 s57, 0x200000, s57
L_att1:
  v_lshrrev_b32 v3, 2, v1
  v_lshlrev_b32 v3, 9, v3
  v_lshl_add_u32 v3, v2, 6, v3
  v_and_b32 v4, 3, v0
  v_lshl_add_u32 v3, v4, 4, v3
  v_add_u32 v3, s57, v3
  v_add_u32 v4, 4096, v3
  s_lshl_b32 s56, s53, 24
  s_add_u32 s56, s56, 14680064
  s_mov_b32 s38, 0x200000
  s_mov_b32 s39, 0x20000
  s_waitcnt lgkmcnt(0)
  s_add_u32 s36, s6, s56
  s_addc_u32 s37, s7, 0

  s_cmp_ge_u32 s54, 7
  s_cbranch_scc1 L_att1_go
  s_cmp_eq_u32 s3, 0
  s_cbranch_scc1 L_att1_go
  s_barrier
  s_cmp_le_u32 s3, 3
  s_cbranch_scc1 L_att1_go
  s_barrier
L_att1_go:
  buffer_load_dwordx4 v[8:11], v3, s[36:39], 0 offen offset:0 nt
  buffer_load_dwordx4 v[12:15], v3, s[36:39], 0 offen offset:256 nt
  buffer_load_dwordx4 v[16:19], v3, s[36:39], 0 offen offset:2048 nt
  buffer_load_dwordx4 v[20:23], v3, s[36:39], 0 offen offset:2304 nt
  buffer_load_dwordx4 v[24:27], v4, s[36:39], 0 offen offset:0 nt
  buffer_load_dwordx4 v[28:31], v4, s[36:39], 0 offen offset:256 nt
  buffer_load_dwordx4 v[32:35], v4, s[36:39], 0 offen offset:2048 nt
  buffer_load_dwordx4 v[36:39], v4, s[36:39], 0 offen offset:2304 nt
  v_lshlrev_b32 v5, 9, v2
  v_lshl_add_u32 v5, v1, 4, v5
  v_add_u32 v5, s57, v5
  v_add_u32 v6, 4096, v5
  s_add_u32 s40, s8, s56
  s_addc_u32 s41, s9, 0
  s_mov_b32 s42, 2097152
  s_mov_b32 s43, 0x20000
  s_cmp_ge_u32 s54, 7
  s_cbranch_scc1 L_att1_k
  s_sub_u32 s55, s3, 1
  s_cmp_ge_u32 s55, 3
  s_cbranch_scc1 L_att1_k
  s_barrier
L_att1_k:
  s_barrier
  buffer_load_dwordx4 v[40:43], v5, s[40:43], 0 offen offset:0 nt
  buffer_load_dwordx4 v[44:47], v5, s[40:43], 0 offen offset:256 nt
  buffer_load_dwordx4 v[48:51], v5, s[40:43], 0 offen offset:2048 nt
  buffer_load_dwordx4 v[52:55], v5, s[40:43], 0 offen offset:2304 nt
  buffer_load_dwordx4 v[56:59], v6, s[40:43], 0 offen offset:0 nt
  buffer_load_dwordx4 v[60:63], v6, s[40:43], 0 offen offset:256 nt
  buffer_load_dwordx4 v[64:67], v6, s[40:43], 0 offen offset:2048 nt
  buffer_load_dwordx4 v[68:71], v6, s[40:43], 0 offen offset:2304 nt
  s_branch L_att2
L_p0:
  s_setprio 3
  s_lshl_b32 s57, s54, 3
  s_add_u32 s57, s57, s53
  s_add_u32 s57, s57, 0
  s_mov_b32 s46, 2048
  s_mov_b32 s47, 1
L_mod:
  s_and_b32 s58, s57, 3
  s_lshr_b32 s57, s57, 2
  v_lshrrev_b32 v3, 3, v1
  v_lshl_add_u32 v3, v2, 1, v3
  v_mul_u32_u24 v3, 5376, v3
  v_and_b32 v4, 7, v0
  v_lshl_add_u32 v3, v4, 4, v3
  s_mul_i32 s56, s58, 602112
  s_lshl_b32 s55, s57, 7
  s_add_u32 s56, s56, s55
  s_mul_i32 s55, s58, 224
  v_min_u32 v5, 55, v0
  v_lshl_add_u32 v5, v5, 2, s55
  s_mov_b32 s38, 2408448
  s_mov_b32 s39, 0x20000
  s_waitcnt lgkmcnt(0)
  s_mov_b32 s36, s24
  s_mov_b32 s37, s25
  global_load_dword v64, v5, s[22:23]
  buffer_load_dwordx4 v[8:11], v3, s[36:39], s56 offen nt
  s_add_u32 s56, s56, 43008
  buffer_load_dwordx4 v[12:15], v3, s[36:39], s56 offen nt
  s_add_u32 s56, s56, 43008
  buffer_load_dwordx4 v[16:19], v3, s[36:39], s56 offen nt
  s_add_u32 s56, s56, 43008
  buffer_load_dwordx4 v[20:23], v3, s[36:39], s56 offen nt
  s_add_u32 s56, s56, 43008
  buffer_load_dwordx4 v[24:27], v3, s[36:39], s56 offen nt
  s_add_u32 s56, s56, 43008
  buffer_load_dwordx4 v[28:31], v3, s[36:39], s56 offen nt
  s_add_u32 s56, s56, 43008
  buffer_load_dwordx4 v[32:35], v3, s[36:39], s56 offen nt
  s_add_u32 s56, s56, 43008
  buffer_load_dwordx4 v[36:39], v3, s[36:39], s56 offen nt
  s_add_u32 s56, s56, 43008
  buffer_load_dwordx4 v[40:43], v3, s[36:39], s56 offen nt
  s_add_u32 s56, s56, 43008
  buffer_load_dwordx4 v[44:47], v3, s[36:39], s56 offen nt
  s_add_u32 s56, s56, 43008
  buffer_load_dwordx4 v[48:51], v3, s[36:39], s56 offen nt
  s_add_u32 s56, s56, 43008
  buffer_load_dwordx4 v[52:55], v3, s[36:39], s56 offen nt
  s_add_u32 s56, s56, 43008
  buffer_load_dwordx4 v[56:59], v3, s[36:39], s56 offen nt
  s_add_u32 s56, s56, 43008
  buffer_load_dwordx4 v[60:63], v3, s[36:39], s56 offen nt
  s_cmp_lg_u32 s47, 1
  s_cbranch_scc1 L_mod2
  s_barrier
  s_branch L_mod2
L_service2:
  s_sub_u32 s54, s54, 14
L_service:
  s_cmp_ge_u32 s54, 8
  s_cbranch_scc1 L_svc_m
  s_cmp_eq_u32 s3, 0
  s_cbranch_scc1 L_w0
  s_cmp_lt_u32 s3, 8
  s_cbranch_scc1 L_ks1
  s_cmp_lt_u32 s3, 12
  s_cbranch_scc1 L_svc_down
  s_cmp_lg_u32 s3, 12
  s_cbranch_scc1 L_exit
  s_setprio 3
  v_min_u32 v3, 55, v0
  v_lshlrev_b32 v3, 4, v3
  s_waitcnt lgkmcnt(0)
  global_load_dwordx4 v[8:11], v3, s[4:5]
  s_branch L_ln2
L_ks1:
  s_sub_u32 s57, s3, 1
  v_lshlrev_b32 v5, 4, v1
  v_lshl_add_u32 v5, v2, 13, v5
  s_and_b32 s59, s54, 1
  s_mul_i32 s59, s59, 7
  s_add_u32 s59, s59, s57
  s_lshl_b32 s56, s59, 18
  s_lshl_b32 s55, s53, 10
  s_add_u32 s56, s56, s55
  s_lshr_b32 s55, s54, 1
  s_lshl_b32 s55, s55, 8
  s_add_u32 s56, s56, s55
  s_mov_b32 s38, 3670016
  s_mov_b32 s39, 0x20000
  s_waitcnt lgkmcnt(0)
  s_mov_b32 s36, s10
  s_mov_b32 s37, s11
  buffer_load_dwordx4 v[8:11], v5, s[36:39], s56 offen nt
  s_add_u32 s56, s56, 32768
  buffer_load_dwordx4 v[12:15], v5, s[36:39], s56 offen nt
  s_add_u32 s56, s56, 32768
  buffer_load_dwordx4 v[16:19], v5, s[36:39], s56 offen nt
  s_add_u32 s56, s56, 32768
  buffer_load_dwordx4 v[20:23], v5, s[36:39], s56 offen nt
  s_add_u32 s56, s56, 32768
  buffer_load_dwordx4 v[24:27], v5, s[36:39], s56 offen nt
  s_add_u32 s56, s56, 32768
  buffer_load_dwordx4 v[28:31], v5, s[36:39], s56 offen nt
  s_add_u32 s56, s56, 32768
  buffer_load_dwordx4 v[32:35], v5, s[36:39], s56 offen nt
  s_add_u32 s56, s56, 32768
  buffer_load_dwordx4 v[36:39], v5, s[36:39], s56 offen nt
  s_branch L_ks2
L_svc_m:
  s_sub_u32 s57, s54, 8
  s_lshl_b32 s57, s57, 3
  s_add_u32 s57, s57, s53
  s_lshl_b32 s46, s3, 8
  s_mov_b32 s47, 0
  s_cmp_ge_u32 s3, 0
  s_cbranch_scc1 L_svc_m2
  s_lshl_b32 s57, s57, 1
  s_add_u32 s57, s57, s3
  s_mov_b32 s47, 2
  s_branch L_mod
L_svc_m2:
  s_cmp_eq_u32 s3, 11
  s_cbranch_scc1 L_z
  s_sub_u32 s55, s3, 4
  s_cmp_ge_u32 s55, 7
  s_cbranch_scc1 L_exit

  s_mul_i32 s57, s57, 7
  s_add_u32 s57, s57, s3
  s_add_u32 s57, s57, 52
  s_barrier
  s_branch L_mod
L_attw:
  s_sub_u32 s57, s3, 12
  s_cmp_ge_u32 s54, 7
  s_cbranch_scc1 L_attw_nobi
  s_barrier
  s_barrier
L_attw_nobi:
  v_mov_b32 v7, 0
  s_cmp_lg_u32 s57, 0
  s_cbranch_scc1 L_attw_noinit
  v_lshlrev_b32 v3, 2, v0
  ds_write_b32 v3, v7 offset:512
  ds_write_b32 v3, v7 offset:0
  s_waitcnt lgkmcnt(0)
L_attw_noinit:
  s_barrier
  s_branch L_attw2
L_done:
L_exit:
  s_endpgm
L_mod2:
  s_load_dword s52, s[30:31], 0
  s_mov_b32 s32, s30
  s_mov_b32 s33, s31
  s_mov_b32 s34, 4194304
  s_mov_b32 s35, 0x20000
  s_mov_b32 s63, 2097152
  s_waitcnt lgkmcnt(0)
  s_add_u32 s52, s52, 1
  s_mul_i32 s55, s52, 0x9E3779B1
  s_and_b32 s48, s52, 0x7f
  s_bfe_u32 s49, s55, 458760
  s_bfe_u32 s50, s55, 458768
  s_bfe_u32 s51, s55, 458776
  s_bitset1_b32 s48, 7
  s_bitset1_b32 s49, 7
  s_bitset1_b32 s50, 7
  s_bitset1_b32 s51, 7
  v_bfe_u32 v72, v0, 3, 1
  v_mul_u32_u24 v72, 0x0202, v72
  v_add_u32 v72, 0x0100, v72
  v_or_b32 v73, 0x0c0c0000, v72
  v_lshlrev_b32 v72, 16, v72
  v_or_b32 v72, 0x0c0c, v72
  v_and_b32 v74, 1, v0
  v_cmp_eq_u32 vcc, 1, v74
  s_nop 1
  v_cndmask_b32 v72, v73, v72, vcc
  v_mov_b32 v73, 0x0c0c0c0c
  v_bfe_u32 v74, v0, 1, 2
  v_cmp_eq_u32 vcc, 0, v74
  s_nop 1
  v_cndmask_b32 v68, v73, v72, vcc
  v_cmp_eq_u32 vcc, 1, v74
  s_nop 1
  v_cndmask_b32 v69, v73, v72, vcc
  v_cmp_eq_u32 vcc, 2, v74
  s_nop 1
  v_cndmask_b32 v70, v73, v72, vcc
  v_cmp_eq_u32 vcc, 3, v74
  s_nop 1
  v_cndmask_b32 v71, v73, v72, vcc
  v_and_b32 v72, 3, v0
  v_lshlrev_b32 v5, 6, v72
  v_lshrrev_b32 v72, 2, v0
  v_lshl_add_u32 v5, v72, 2, v5
  v_add_u32 v5, s46, v5
  v_lshl_add_u32 v6, v2, 6, s46
  s_mul_i32 s55, s58, 10752
  s_lshl_b32 s56, s57, 8
  s_add_u32 s55, s55, s56
  s_add_u32 s55, s55, 4096
  v_lshlrev_b32 v7, 5, v1
  v_lshl_add_u32 v7, v2, 4, v7
  v_add_u32 v7, s55, v7
  s_mov_b32 s56, 0xbfb8aa3b
  s_waitcnt vmcnt(14)

  v_lshlrev_b32 v65, 16, v64
  v_and_b32 v64, 0xffff0000, v64
  v_mul_f32 v66, s56, v65
  v_mul_f32 v67, s56, v64
  v_exp_f32 v66, v66
  v_exp_f32 v67, v67
  v_add_f32 v66, 1.0, v66
  v_add_f32 v67, 1.0, v67
  v_rcp_f32 v66, v66
  v_rcp_f32 v67, v67
  v_mul_f32 v65, v65, v66
  v_mul_f32 v64, v64, v67
  v_cvt_pk_bf16_f32 v64, v65, v64
  ds_write_b32 v5, v64 offset:0
  ds_read_b128 v[72:75], v6 offset:0
  ds_read_b128 v[76:79], v6 offset:16
  ds_read_b128 v[80:83], v6 offset:32
  ds_read_b128 v[84:87], v6 offset:48
  s_and_b32 s40, s48, 15
  s_and_b32 s41, s49, 15
  s_and_b32 s42, s50, 15
  s_and_b32 s43, s51, 15
  v_mov_b32 v5, 0xfffffff0
  s_waitcnt lgkmcnt(0)
  v_perm_b32 v88, v72, v72, v68
  v_perm_b32 v89, v72, v72, v69
  v_perm_b32 v90, v72, v72, v70
  v_perm_b32 v91, v72, v72, v71
  v_perm_b32 v92, v73, v73, v68
  v_perm_b32 v93, v73, v73, v69
  v_perm_b32 v94, v73, v73, v70
  v_perm_b32 v95, v73, v73, v71
  s_waitcnt vmcnt(13)
  v_mfma_f32_16x16x32_bf16 v[104:107], v[88:91], v[8:11], 0
  v_perm_b32 v96, v74, v74, v68
  v_perm_b32 v97, v74, v74, v69
  v_perm_b32 v98, v74, v74, v70
  v_perm_b32 v99, v74, v74, v71
  s_waitcnt vmcnt(12)
  v_mfma_f32_16x16x32_bf16 v[104:107], v[92:95], v[12:15], v[104:107]
  v_perm_b32 v100, v75, v75, v68
  v_perm_b32 v101, v75, v75, v69
  v_perm_b32 v102, v75, v75, v70
  v_perm_b32 v103, v75, v75, v71
  s_waitcnt vmcnt(11)
  v_mfma_f32_16x16x32_bf16 v[104:107], v[96:99], v[16:19], v[104:107]
  v_perm_b32 v88, v76, v76, v68
  v_perm_b32 v89, v76, v76, v69
  v_perm_b32 v90, v76, v76, v70
  v_perm_b32 v91, v76, v76, v71
  s_waitcnt vmcnt(10)
  v_mfma_f32_16x16x32_bf16 v[104:107], v[100:103], v[20:23], v[104:107]
  v_perm_b32 v92, v77, v77, v68
  v_perm_b32 v93, v77, v77, v69
  v_perm_b32 v94, v77, v77, v70
  v_perm_b32 v95, v77, v77, v71
  s_waitcnt vmcnt(9)
  v_mfma_f32_16x16x32_bf16 v[104:107], v[88:91], v[24:27], v[104:107]
  v_perm_b32 v96, v78, v78, v68
  v_perm_b32 v97, v78, v78, v69
  v_perm_b32 v98, v78, v78, v70
  v_perm_b32 v99, v78, v78, v71
  s_waitcnt vmcnt(8)
  v_mfma_f32_16x16x32_bf16 v[104:107], v[92:95], v[28:31], v[104:107]
  v_perm_b32 v100, v79, v79, v68
  v_perm_b32 v101, v79, v79, v69
  v_perm_b32 v102, v79, v79, v70
  v_perm_b32 v103, v79, v79, v71
  s_waitcnt vmcnt(7)
  v_mfma_f32_16x16x32_bf16 v[104:107], v[96:99], v[32:35], v[104:107]
  v_perm_b32 v88, v80, v80, v68
  v_perm_b32 v89, v80, v80, v69
  v_perm_b32 v90, v80, v80, v70
  v_perm_b32 v91, v80, v80, v71
  s_waitcnt vmcnt(6)
  v_mfma_f32_16x16x32_bf16 v[104:107], v[100:103], v[36:39], v[104:107]
  v_perm_b32 v92, v81, v81, v68
  v_perm_b32 v93, v81, v81, v69
  v_perm_b32 v94, v81, v81, v70
  v_perm_b32 v95, v81, v81, v71
  s_waitcnt vmcnt(5)
  v_mfma_f32_16x16x32_bf16 v[104:107], v[88:91], v[40:43], v[104:107]
  v_perm_b32 v96, v82, v82, v68
  v_perm_b32 v97, v82, v82, v69
  v_perm_b32 v98, v82, v82, v70
  v_perm_b32 v99, v82, v82, v71
  s_waitcnt vmcnt(4)
  v_mfma_f32_16x16x32_bf16 v[104:107], v[92:95], v[44:47], v[104:107]
  v_perm_b32 v100, v83, v83, v68
  v_perm_b32 v101, v83, v83, v69
  v_perm_b32 v102, v83, v83, v70
  v_perm_b32 v103, v83, v83, v71
  s_waitcnt vmcnt(3)
  v_mfma_f32_16x16x32_bf16 v[104:107], v[96:99], v[48:51], v[104:107]
  v_perm_b32 v88, v84, v84, v68
  v_perm_b32 v89, v84, v84, v69
  v_perm_b32 v90, v84, v84, v70
  v_perm_b32 v91, v84, v84, v71
  s_waitcnt vmcnt(2)
  v_mfma_f32_16x16x32_bf16 v[104:107], v[100:103], v[52:55], v[104:107]
  v_perm_b32 v92, v85, v85, v68
  v_perm_b32 v93, v85, v85, v69
  v_perm_b32 v94, v85, v85, v70
  v_perm_b32 v95, v85, v85, v71
  s_waitcnt vmcnt(1)
  v_mfma_f32_16x16x32_bf16 v[104:107], v[88:91], v[56:59], v[104:107]
  s_waitcnt vmcnt(0)
  v_mfma_f32_16x16x32_bf16 v[104:107], v[92:95], v[60:63], v[104:107]
  s_nop 7
  v_permlane32_swap_b32 v104, v105
  v_permlane32_swap_b32 v106, v107
  s_nop 0
  v_add_f32_dpp v104, v105, v104 row_ror:8 row_mask:0xf bank_mask:0xf
  v_add_f32_dpp v106, v107, v106 row_ror:8 row_mask:0xf bank_mask:0xf
  s_nop 0
  v_permlane32_swap_b32 v104, v105
  v_permlane32_swap_b32 v106, v107
  v_add_u32 v104, 8, v104
  v_add_u32 v105, 8, v105
  v_add_u32 v106, 8, v106
  v_add_u32 v107, 8, v107
  v_and_or_b32 v108, v104, v5, s40
  v_and_or_b32 v109, v105, v5, s41
  v_and_or_b32 v110, v106, v5, s42
  v_and_or_b32 v111, v107, v5, s43
  s_mov_b64 exec, 0x00ff00ff
  buffer_store_dwordx4 v[108:111], v7, s[32:35], 0 offen sc1
  s_mov_b64 exec, -1
  s_cmp_eq_u32 s47, 0
  s_cbranch_scc1 L_done
  s_barrier
  s_cmp_eq_u32 s47, 2
  s_cbranch_scc1 L_done
  s_setprio 0
  s_mov_b32 s57, 0x200000
  s_branch L_att1
L_ln2:
  s_mov_b32 s60, -1
  s_mov_b32 s61, 0x00ffffff
  v_mov_b32 v20, 0
  v_mov_b32 v21, 0
  v_lshlrev_b32 v3, 5, v0
  s_waitcnt vmcnt(0)
  v_lshlrev_b32 v12, 16, v8
  v_and_b32 v13, 0xffff0000, v8
  v_lshlrev_b32 v14, 16, v9
  v_and_b32 v15, 0xffff0000, v9
  v_lshlrev_b32 v16, 16, v10
  v_and_b32 v17, 0xffff0000, v10
  v_lshlrev_b32 v18, 16, v11
  v_and_b32 v19, 0xffff0000, v11
  s_mov_b64 exec, s[60:61]
  v_add_f32 v20, v12, v13
  v_add_f32 v22, v14, v15
  v_add_f32 v23, v16, v17
  v_add_f32 v24, v18, v19
  v_add_f32 v20, v20, v22
  v_add_f32 v23, v23, v24
  v_add_f32 v20, v20, v23
  s_mov_b64 exec, -1
  s_nop 0
  v_add_f32_dpp v20, v20, v20 quad_perm:[1,0,3,2] row_mask:0xf bank_mask:0xf
  s_nop 1
  v_add_f32_dpp v20, v20, v20 quad_perm:[2,3,0,1] row_mask:0xf bank_mask:0xf
  s_nop 1
  v_add_f32_dpp v20, v20, v20 row_half_mirror row_mask:0xf bank_mask:0xf
  s_nop 1
  v_add_f32_dpp v20, v20, v20 row_mirror row_mask:0xf bank_mask:0xf
  v_mov_b32 v22, v20
  s_nop 1
  v_permlane16_swap_b32 v20, v22
  v_add_f32 v20, v20, v22
  v_mov_b32 v22, v20
  s_nop 1
  v_permlane32_swap_b32 v20, v22
  v_add_f32 v20, v20, v22
  v_mul_f32 v20, 0x3b124925, v20
  s_mov_b64 exec, s[60:61]
  v_sub_f32 v24, v12, v20
  v_sub_f32 v25, v13, v20
  v_sub_f32 v26, v14, v20
  v_sub_f32 v27, v15, v20
  v_sub_f32 v28, v16, v20
  v_sub_f32 v29, v17, v20
  v_sub_f32 v30, v18, v20
  v_sub_f32 v31, v19, v20
  v_fmac_f32 v21, v24, v24
  v_fmac_f32 v21, v25, v25
  v_fmac_f32 v21, v26, v26
  v_fmac_f32 v21, v27, v27
  v_fmac_f32 v21, v28, v28
  v_fmac_f32 v21, v29, v29
  v_fmac_f32 v21, v30, v30
  v_fmac_f32 v21, v31, v31
  s_mov_b64 exec, -1
  s_nop 0
  v_add_f32_dpp v21, v21, v21 quad_perm:[1,0,3,2] row_mask:0xf bank_mask:0xf
  s_nop 1
  v_add_f32_dpp v21, v21, v21 quad_perm:[2,3,0,1] row_mask:0xf bank_mask:0xf
  s_nop 1
  v_add_f32_dpp v21, v21, v21 row_half_mirror row_mask:0xf bank_mask:0xf
  s_nop 1
  v_add_f32_dpp v21, v21, v21 row_mirror row_mask:0xf bank_mask:0xf
  v_mov_b32 v22, v21
  s_nop 1
  v_permlane16_swap_b32 v21, v22
  v_add_f32 v21, v21, v22
  v_mov_b32 v22, v21
  s_nop 1
  v_permlane32_swap_b32 v21, v22
  v_add_f32 v21, v21, v22
  v_mul_f32 v21, 0x3b124925, v21
  v_mov_b32 v4, 0
  v_cvt_pk_bf16_f32 v20, v20, v20
  v_lshlrev_b32 v20, 16, v20
  v_cvt_pk_bf16_f32 v21, v21, v21
  v_lshlrev_b32 v21, 16, v21
  ds_write_b32 v4, v20 offset:8256
  v_add_f32 v21, 0x3727c5ac, v21
  v_cvt_pk_bf16_f32 v21, v21, v21
  v_lshlrev_b32 v21, 16, v21
  v_sqrt_f32 v21, v21
  s_nop 0
  v_cvt_pk_bf16_f32 v21, v21, v21
  v_lshlrev_b32 v21, 16, v21
  v_rcp_f32 v22, v21
  v_sub_f32 v12, v12, v20
  v_sub_f32 v13, v13, v20
  v_sub_f32 v14, v14, v20
  v_sub_f32 v15, v15, v20
  v_sub_f32 v16, v16, v20
  v_sub_f32 v17, v17, v20
  v_sub_f32 v18, v18, v20
  v_sub_f32 v19, v19, v20
  v_cvt_pk_bf16_f32 v12, v12, v12
  v_lshlrev_b32 v12, 16, v12
  v_cvt_pk_bf16_f32 v13, v13, v13
  v_lshlrev_b32 v13, 16, v13
  v_cvt_pk_bf16_f32 v14, v14, v14
  v_lshlrev_b32 v14, 16, v14
  v_cvt_pk_bf16_f32 v15, v15, v15
  v_lshlrev_b32 v15, 16, v15
  v_cvt_pk_bf16_f32 v16, v16, v16
  v_lshlrev_b32 v16, 16, v16
  v_cvt_pk_bf16_f32 v17, v17, v17
  v_lshlrev_b32 v17, 16, v17
  v_cvt_pk_bf16_f32 v18, v18, v18
  v_lshlrev_b32 v18, 16, v18
  v_cvt_pk_bf16_f32 v19, v19, v19
  v_lshlrev_b32 v19, 16, v19
  v_mul_f32 v24, v12, v22
  v_mul_f32 v25, v13, v22
  v_mul_f32 v26, v14, v22
  v_mul_f32 v27, v15, v22
  v_mul_f32 v28, v16, v22
  v_mul_f32 v29, v17, v22
  v_mul_f32 v30, v18, v22
  v_mul_f32 v31, v19, v22
  v_fma_f32 v12, -v24, v21, v12
  v_fma_f32 v13, -v25, v21, v13
  v_fma_f32 v14, -v26, v21, v14
  v_fma_f32 v15, -v27, v21, v15
  v_fma_f32 v16, -v28, v21, v16
  v_fma_f32 v17, -v29, v21, v17
  v_fma_f32 v18, -v30, v21, v18
  v_fma_f32 v19, -v31, v21, v19
  v_fmac_f32 v24, v12, v22
  v_fmac_f32 v25, v13, v22
  v_fmac_f32 v26, v14, v22
  v_fmac_f32 v27, v15, v22
  v_fmac_f32 v28, v16, v22
  v_fmac_f32 v29, v17, v22
  v_fmac_f32 v30, v18, v22
  v_fmac_f32 v31, v19, v22
  v_cvt_pk_bf16_f32 v24, v24, v24
  v_lshlrev_b32 v24, 16, v24
  v_cvt_pk_bf16_f32 v25, v25, v25
  v_lshlrev_b32 v25, 16, v25
  v_cvt_pk_bf16_f32 v26, v26, v26
  v_lshlrev_b32 v26, 16, v26
  v_cvt_pk_bf16_f32 v27, v27, v27
  v_lshlrev_b32 v27, 16, v27
  v_cvt_pk_bf16_f32 v28, v28, v28
  v_lshlrev_b32 v28, 16, v28
  v_cvt_pk_bf16_f32 v29, v29, v29
  v_lshlrev_b32 v29, 16, v29
  v_cvt_pk_bf16_f32 v30, v30, v30
  v_lshlrev_b32 v30, 16, v30
  v_cvt_pk_bf16_f32 v31, v31, v31
  v_lshlrev_b32 v31, 16, v31
  s_mov_b64 exec, s[60:61]
  ds_write_b128 v3, v[24:27] offset:8448
  ds_write_b128 v3, v[28:31] offset:8464
  s_mov_b64 exec, -1
  s_waitcnt lgkmcnt(0)
  s_barrier
  s_endpgm
L_ks2:
  s_load_dword s52, s[30:31], 0
  s_mov_b32 s32, s30
  s_mov_b32 s33, s31
  s_mov_b32 s34, 4194304
  s_mov_b32 s35, 0x20000
  s_mov_b32 s63, 2097152
  s_waitcnt lgkmcnt(0)
  s_add_u32 s52, s52, 1
  s_mul_i32 s55, s52, 0x9E3779B1
  s_and_b32 s48, s52, 0x7f
  s_bfe_u32 s49, s55, 458760
  s_bfe_u32 s50, s55, 458768
  s_bfe_u32 s51, s55, 458776
  s_bitset1_b32 s48, 7
  s_bitset1_b32 s49, 7
  s_bitset1_b32 s50, 7
  s_bitset1_b32 s51, 7
  s_and_b32 s6, s48, 15
  s_and_b32 s7, s49, 15
  s_and_b32 s8, s50, 15
  s_and_b32 s9, s51, 15
  s_lshl_b32 s55, s59, 7
  v_and_b32 v84, 7, v0
  v_lshl_add_u32 v68, v84, 4, s55
  v_lshl_add_u32 v69, v2, 2, v68
  v_lshrrev_b32 v84, 3, v1
  v_mul_u32_u24 v84, 1792, v84
  v_add_u32 v68, v68, v84
  v_mul_u32_u24 v84, 10752, v2
  v_add_u32 v68, v68, v84
  v_add_u32 v68, 4096, v68
  s_lshl_b32 s55, s3, 8
  v_lshl_add_u32 v70, v2, 6, s55
  v_lshl_add_u32 v71, v1, 2, v70
  s_lshl_b32 s55, s57, 9
  v_lshl_add_u32 v72, v1, 5, s55
  v_lshl_add_u32 v72, v2, 4, v72
  v_mov_b32 v73, 1.0
  s_waitcnt vmcnt(5)
  s_barrier
  ds_read_b32 v75, v69 offset:8448
  buffer_load_dwordx4 v[40:43], v68, s[32:35], 0 offen sc1
  s_mov_b32 s46, 0x05040100
  s_mov_b32 s47, 0x07060302
  s_mov_b32 s42, 0xffff0000
  s_mov_b32 s43, 0
  s_mov_b32 s60, -1
  s_mov_b32 s61, 0
  s_waitcnt vmcnt(1)
  v_perm_b32 v84, v12, v8, s46
  v_perm_b32 v88, v12, v8, s47
  v_perm_b32 v85, v20, v16, s46
  v_perm_b32 v89, v20, v16, s47
  v_perm_b32 v86, v28, v24, s46
  v_perm_b32 v90, v28, v24, s47
  v_perm_b32 v87, v36, v32, s46
  v_perm_b32 v91, v36, v32, s47
  v_perm_b32 v92, v13, v9, s46
  v_perm_b32 v96, v13, v9, s47
  v_perm_b32 v93, v21, v17, s46
  v_perm_b32 v97, v21, v17, s47
  v_perm_b32 v94, v29, v25, s46
  v_perm_b32 v98, v29, v25, s47
  v_perm_b32 v95, v37, v33, s46
  v_perm_b32 v99, v37, v33, s47
  v_perm_b32 v100, v14, v10, s46
  v_perm_b32 v104, v14, v10, s47
  v_perm_b32 v101, v22, v18, s46
  v_perm_b32 v105, v22, v18, s47
  v_perm_b32 v102, v30, v26, s46
  v_perm_b32 v106, v30, v26, s47
  v_perm_b32 v103, v38, v34, s46
  v_perm_b32 v107, v38, v34, s47
  v_perm_b32 v108, v15, v11, s46
  v_perm_b32 v112, v15, v11, s47
  v_perm_b32 v109, v23, v19, s46
  v_perm_b32 v113, v23, v19, s47
  v_perm_b32 v110, v31, v27, s46
  v_perm_b32 v114, v31, v27, s47
  v_perm_b32 v111, v39, v35, s46
  v_perm_b32 v115, v39, v35, s47
  s_mov_b32 s62, 0
  s_mov_b64 exec, -1
  s_branch L_h_pi_36
L_h_32:
  buffer_load_dwordx4 v[40:43], v68, s[32:35], 0 offen sc1
L_h_pi_36:
  s_waitcnt vmcnt(0)
  v_xor_b32 v44, s6, v40
  v_xor_b32 v45, s7, v41
  v_xor_b32 v46, s8, v42
  v_xor_b32 v47, s9, v43
  v_or_b32 v48, v44, v45
  v_or3_b32 v48, v46, v47, v48
  v_and_b32 v48, 15, v48
  v_cmp_ne_u32 vcc, 0, v48
  s_cbranch_vccz L_h_a_33
  s_add_u32 s62, s62, 1
  s_sleep 1
  s_cmp_lt_u32 s62, 2097152
  s_cbranch_scc1 L_h_32
L_h_a_33:
L_h_d_35:
  v_permlane32_swap_b32 v44, v46
  v_permlane32_swap_b32 v45, v47
  v_add_f32 v44, v44, v46
  v_add_f32 v45, v45, v47
  s_nop 1
  v_permlane16_swap_b32 v44, v45
  v_add_f32 v44, v44, v45
  v_cvt_pk_bf16_f32 v44, v44, v44
  v_lshlrev_b32 v44, 16, v44
  s_nop 1
  v_add_f32_dpp v45, v44, v73 row_ror:8 row_mask:0xf bank_mask:0xf
  v_cvt_pk_bf16_f32 v45, v45, v45
  v_lshlrev_b32 v45, 16, v45
  s_waitcnt lgkmcnt(0)
  v_mul_f32 v45, v75, v45
  v_cvt_pk_bf16_f32 v45, v45, v45
  v_lshlrev_b32 v45, 16, v45
  v_add_f32 v45, v45, v44
  s_nop 1
  v_mov_b32_dpp v46, v45 quad_perm:[1,0,3,2] row_mask:0xf bank_mask:0xf
  v_cvt_pk_bf16_f32 v45, v45, v46
  s_nop 1
  v_mov_b32_dpp v120, v45 row_newbcast:0 row_mask:0xf bank_mask:0xf
  v_mov_b32_dpp v121, v45 row_newbcast:2 row_mask:0xf bank_mask:0xf
  v_mov_b32_dpp v122, v45 row_newbcast:4 row_mask:0xf bank_mask:0xf
  v_mov_b32_dpp v123, v45 row_newbcast:6 row_mask:0xf bank_mask:0xf
  s_nop 1
  v_mfma_f32_16x16x32_bf16 v[8:11], v[120:123], v[84:87], 0
  v_mfma_f32_16x16x32_bf16 v[24:27], v[120:123], v[100:103], 0
  v_mfma_f32_16x16x32_bf16 v[12:15], v[120:123], v[88:91], 0
  v_mfma_f32_16x16x32_bf16 v[28:31], v[120:123], v[104:107], 0
  v_mfma_f32_16x16x32_bf16 v[16:19], v[120:123], v[92:95], 0
  v_mfma_f32_16x16x32_bf16 v[32:35], v[120:123], v[108:111], 0
  v_mfma_f32_16x16x32_bf16 v[20:23], v[120:123], v[96:99], 0
  v_mfma_f32_16x16x32_bf16 v[36:39], v[120:123], v[112:115], 0
  s_nop 1
  v_cndmask_b32 v40, v8, v24, s[42:43]
  s_nop 0
  v_cndmask_b32 v41, v12, v28, s[42:43]
  s_nop 0
  v_cndmask_b32 v42, v16, v32, s[42:43]
  s_nop 0
  v_cndmask_b32 v43, v20, v36, s[42:43]
  s_mov_b64 exec, s[60:61]
  ds_write_b128 v72, v[40:43] offset:4096
  s_mov_b64 exec, -1
  s_waitcnt lgkmcnt(0)
  s_barrier
  s_lshl_b32 s58, s53, 3
  s_mul_i32 s55, s53, 6
  s_add_u32 s55, s55, 8
  s_cmp_lt_u32 s53, 4
  s_cselect_b32 s58, s58, s55
  s_cselect_b32 s55, 8, 6
  s_add_u32 s58, s58, s54
  s_cmp_lt_u32 s54, s55
  s_cselect_b32 s58, s58, 56
  s_cmp_ge_u32 s58, 56
  s_cbranch_scc1 L_done
  v_lshrrev_b32 v3, 3, v1
  v_lshl_add_u32 v3, v2, 1, v3
  v_lshl_add_u32 v7, v1, 2, v2
  s_lshl_b32 s55, s57, 7
  v_lshl_add_u32 v6, v7, 1, s55
  global_load_ushort v77, v6, s[4:5]
  s_mov_b32 s36, s16
  s_mov_b32 s37, s17
  s_mov_b32 s38, 1605632
  s_mov_b32 s39, 0x20000
  s_mov_b32 s40, s18
  s_mov_b32 s41, s19
  s_mov_b32 s42, 1605632
  s_mov_b32 s43, 0x20000
  v_lshrrev_b32 v3, 3, v1
  v_lshl_add_u32 v3, v3, 5, v2
  v_mul_u32_u24 v5, 3584, v3
  v_and_b32 v84, 3, v0
  v_lshl_add_u32 v5, v84, 4, v5
  s_mul_i32 s56, s57, 229376
  s_lshl_b32 s55, s58, 6
  s_add_u32 s56, s56, s55
  s_mov_b32 s59, s56
  s_mov_b32 s60, 0x0f0f0f0f
  s_mov_b32 s61, 0x0f0f0f0f
  s_barrier
  s_mov_b64 exec, s[60:61]
  buffer_load_dwordx4 v[8:11], v5, s[36:39], s56 offen nt
  s_add_u32 s56, s56, 14336
  buffer_load_dwordx4 v[12:15], v5, s[36:39], s56 offen nt
  s_add_u32 s56, s56, 14336
  buffer_load_dwordx4 v[16:19], v5, s[36:39], s56 offen nt
  s_add_u32 s56, s56, 14336
  buffer_load_dwordx4 v[20:23], v5, s[36:39], s56 offen nt
  s_add_u32 s56, s56, 14336
  buffer_load_dwordx4 v[24:27], v5, s[36:39], s56 offen nt
  s_add_u32 s56, s56, 14336
  buffer_load_dwordx4 v[28:31], v5, s[36:39], s56 offen nt
  s_add_u32 s56, s56, 14336
  buffer_load_dwordx4 v[32:35], v5, s[36:39], s56 offen nt
  s_add_u32 s56, s56, 14336
  buffer_load_dwordx4 v[36:39], v5, s[36:39], s56 offen nt
  s_not_b64 exec, exec
  buffer_load_dwordx4 v[8:11], v5, s[40:43], s59 offen nt
  s_add_u32 s59, s59, 14336
  buffer_load_dwordx4 v[12:15], v5, s[40:43], s59 offen nt
  s_add_u32 s59, s59, 14336
  buffer_load_dwordx4 v[16:19], v5, s[40:43], s59 offen nt
  s_add_u32 s59, s59, 14336
  buffer_load_dwordx4 v[20:23], v5, s[40:43], s59 offen nt
  s_add_u32 s59, s59, 14336
  buffer_load_dwordx4 v[24:27], v5, s[40:43], s59 offen nt
  s_add_u32 s59, s59, 14336
  buffer_load_dwordx4 v[28:31], v5, s[40:43], s59 offen nt
  s_add_u32 s59, s59, 14336
  buffer_load_dwordx4 v[32:35], v5, s[40:43], s59 offen nt
  s_add_u32 s59, s59, 14336
  buffer_load_dwordx4 v[36:39], v5, s[40:43], s59 offen nt
  s_mov_b64 exec, -1
  s_lshl_b32 s55, s57, 8
  s_add_u32 s55, s55, 4096
  v_mul_u32_u24 v78, 10752, v2
  v_lshl_add_u32 v78, v1, 4, v78
  v_add_u32 v78, s55, v78
  s_lshl_b32 s55, s3, 8
  v_and_b32 v84, 1, v2
  v_lshl_add_u32 v79, v84, 6, s55
  v_and_b32 v84, 1, v1
  v_lshl_add_u32 v79, v84, 5, v79
  v_lshrrev_b32 v84, 1, v2
  v_lshl_add_u32 v79, v84, 4, v79
  v_lshrrev_b32 v84, 1, v1
  v_lshl_add_u32 v79, v84, 1, v79
  v_and_b32 v84, 3, v1
  v_lshl_add_u32 v6, v84, 6, s55
  v_lshl_add_u32 v6, v2, 4, v6
  s_lshl_b32 s55, s57, 9
  v_lshl_add_u32 v76, v1, 5, s55
  v_add_u32 v5, 4096, v78
  s_mov_b32 s62, 0
L_m_37:
  buffer_load_dwordx4 v[40:43], v78, s[32:35], 0 offen offset:3584 sc1
  buffer_load_dwordx4 v[44:47], v5, s[32:35], 0 offen offset:1280 sc1
  buffer_load_dwordx4 v[48:51], v5, s[32:35], 0 offen offset:3072 sc1
  s_waitcnt vmcnt(2)
  v_xor_b32 v52, s6, v40
  v_xor_b32 v53, s7, v41
  v_xor_b32 v54, s8, v42
  v_xor_b32 v55, s9, v43
  v_or_b32 v64, v52, v53
  v_or3_b32 v64, v54, v55, v64
  s_waitcnt vmcnt(1)
  v_xor_b32 v56, s6, v44
  v_xor_b32 v57, s7, v45
  v_xor_b32 v58, s8, v46
  v_xor_b32 v59, s9, v47
  v_or3_b32 v64, v56, v57, v64
  v_or3_b32 v64, v58, v59, v64
  s_waitcnt vmcnt(0)
  v_xor_b32 v60, s6, v48
  v_xor_b32 v61, s7, v49
  v_xor_b32 v62, s8, v50
  v_xor_b32 v63, s9, v51
  v_or3_b32 v64, v60, v61, v64
  v_or3_b32 v64, v62, v63, v64
  v_and_b32 v64, 15, v64
  v_cmp_ne_u32 vcc, 0, v64
  s_cbranch_vccz L_m_a_38
  s_add_u32 s62, s62, 1
  s_sleep 1
  s_cmp_lt_u32 s62, 2097152
  s_cbranch_scc1 L_m_37
L_m_a_38:
L_m_d_40:
  v_mov_b32 v4, 0
  ds_read_b32 v71, v4 offset:8256
  v_permlane32_swap_b32 v52, v54
  v_permlane32_swap_b32 v53, v55
  v_permlane32_swap_b32 v56, v58
  v_permlane32_swap_b32 v57, v59
  v_permlane32_swap_b32 v60, v62
  v_permlane32_swap_b32 v61, v63
  v_add_f32 v52, v52, v54
  v_add_f32 v53, v53, v55
  v_add_f32 v56, v56, v58
  v_add_f32 v57, v57, v59
  v_add_f32 v60, v60, v62
  v_add_f32 v61, v61, v63
  v_permlane16_swap_b32 v52, v53
  v_permlane16_swap_b32 v56, v57
  v_permlane16_swap_b32 v60, v61
  v_add_f32 v52, v52, v53
  v_add_f32 v56, v56, v57
  v_add_f32 v60, v60, v61
  v_lshlrev_b32 v77, 16, v77
  v_cvt_pk_bf16_f32 v72, v52, v52
  v_lshlrev_b32 v72, 16, v72
  v_cvt_pk_bf16_f32 v74, v60, v60
  v_lshlrev_b32 v74, 16, v74
  v_add_f32 v74, 1.0, v74
  v_cvt_pk_bf16_f32 v74, v74, v74
  v_lshlrev_b32 v74, 16, v74
  v_mov_b32_dpp v73, v56 quad_perm:[1,0,3,2] row_mask:0xf bank_mask:0xf
  s_nop 0
  v_mov_b32_dpp v75, v74 quad_perm:[1,0,3,2] row_mask:0xf bank_mask:0xf
  s_mov_b32 s46, 0x05040100
  s_mov_b32 s47, 0x07060302
  v_cvt_pk_bf16_f32 v73, v56, v73
  v_cvt_pk_bf16_f32 v79, v74, v75
  v_perm_b32 v84, v12, v8, s46
  v_perm_b32 v88, v12, v8, s47
  v_perm_b32 v85, v20, v16, s46
  v_perm_b32 v89, v20, v16, s47
  v_perm_b32 v86, v28, v24, s46
  v_perm_b32 v90, v28, v24, s47
  v_perm_b32 v87, v36, v32, s46
  v_perm_b32 v91, v36, v32, s47
  v_perm_b32 v92, v13, v9, s46
  v_perm_b32 v96, v13, v9, s47
  v_perm_b32 v93, v21, v17, s46
  v_perm_b32 v97, v21, v17, s47
  v_perm_b32 v94, v29, v25, s46
  v_perm_b32 v98, v29, v25, s47
  v_perm_b32 v95, v37, v33, s46
  v_perm_b32 v99, v37, v33, s47
  v_perm_b32 v100, v14, v10, s46
  v_perm_b32 v104, v14, v10, s47
  v_perm_b32 v101, v22, v18, s46
  v_perm_b32 v105, v22, v18, s47
  v_perm_b32 v102, v30, v26, s46
  v_perm_b32 v106, v30, v26, s47
  v_perm_b32 v103, v38, v34, s46
  v_perm_b32 v107, v38, v34, s47
  v_perm_b32 v108, v15, v11, s46
  v_perm_b32 v112, v15, v11, s47
  v_perm_b32 v109, v23, v19, s46
  v_perm_b32 v113, v23, v19, s47
  v_perm_b32 v110, v31, v27, s46
  v_perm_b32 v114, v31, v27, s47
  v_perm_b32 v111, v39, v35, s46
  v_perm_b32 v115, v39, v35, s47
  v_mov_b32_dpp v120, v79 row_newbcast:0 row_mask:0xf bank_mask:0x1
  v_mov_b32_dpp v121, v79 row_newbcast:2 row_mask:0xf bank_mask:0x1
  v_mov_b32_dpp v122, v79 row_newbcast:4 row_mask:0xf bank_mask:0x1
  v_mov_b32_dpp v123, v79 row_newbcast:6 row_mask:0xf bank_mask:0x1
  v_mov_b32_dpp v120, v79 row_newbcast:8 row_mask:0xf bank_mask:0x4
  v_mov_b32_dpp v121, v79 row_newbcast:10 row_mask:0xf bank_mask:0x4
  v_mov_b32_dpp v122, v79 row_newbcast:12 row_mask:0xf bank_mask:0x4
  v_mov_b32_dpp v123, v79 row_newbcast:14 row_mask:0xf bank_mask:0x4
  v_mov_b32_dpp v120, v73 row_newbcast:0 row_mask:0xf bank_mask:0x2
  v_mov_b32_dpp v121, v73 row_newbcast:2 row_mask:0xf bank_mask:0x2
  v_mov_b32_dpp v122, v73 row_newbcast:4 row_mask:0xf bank_mask:0x2
  v_mov_b32_dpp v123, v73 row_newbcast:6 row_mask:0xf bank_mask:0x2
  v_mov_b32_dpp v120, v73 row_newbcast:8 row_mask:0xf bank_mask:0x8
  v_mov_b32_dpp v121, v73 row_newbcast:10 row_mask:0xf bank_mask:0x8
  v_mov_b32_dpp v122, v73 row_newbcast:12 row_mask:0xf bank_mask:0x8
  v_mov_b32_dpp v123, v73 row_newbcast:14 row_mask:0xf bank_mask:0x8
  s_lshl_b32 s55, s57, 8
  s_mul_i32 s59, s53, 16384
  s_add_u32 s55, s55, s59
  s_add_u32 s55, s55, 393216
  v_mul_u32_u24 v78, 1792, v2
  v_lshl_add_u32 v78, v1, 4, v78
  v_add_u32 v78, s55, v78
  s_mov_b32 s59, 7168
  s_lshl_b32 s55, s57, 3
  v_lshrrev_b32 v3, 3, v0
  v_add_u32 v3, s55, v3
  v_and_b32 v5, 1, v2
  v_lshl_add_u32 v6, v5, 12, v76
  v_lshl_add_u32 v76, v5, 4, v76
  s_mov_b32 s42, 1
  s_mov_b32 s43, 1
  s_mov_b32 s44, 0xffff0000
  s_mov_b32 s45, 0xffff0000
  s_mov_b32 s60, 0x00ff00ff
  s_mov_b32 s61, 0xff00ff00
  s_setprio 3
  v_mfma_f32_16x16x32_bf16 v[8:11], v[120:123], v[84:87], 0
  v_mfma_f32_16x16x32_bf16 v[24:27], v[120:123], v[100:103], 0
  v_mfma_f32_16x16x32_bf16 v[12:15], v[120:123], v[88:91], 0
  v_mfma_f32_16x16x32_bf16 v[28:31], v[120:123], v[104:107], 0
  v_mfma_f32_16x16x32_bf16 v[16:19], v[120:123], v[92:95], 0
  v_mfma_f32_16x16x32_bf16 v[32:35], v[120:123], v[108:111], 0
  v_mfma_f32_16x16x32_bf16 v[20:23], v[120:123], v[96:99], 0
  v_mfma_f32_16x16x32_bf16 v[36:39], v[120:123], v[112:115], 0
  s_nop 0
  v_mov_b32 v40, v8
  s_nop 0
  v_mov_b32 v41, v12
  s_nop 0
  v_mov_b32 v42, v16
  s_nop 0
  v_mov_b32 v43, v20
  v_mov_b32 v44, v24
  v_mov_b32 v45, v28
  v_mov_b32 v46, v32
  v_mov_b32 v47, v36
  s_mov_b64 exec, s[60:61]
  ds_write_b128 v6, v[40:43] offset:12288
  ds_write_b128 v6, v[44:47] offset:12304
  s_mov_b64 exec, -1
  s_waitcnt lgkmcnt(0)
  s_barrier
  s_mov_b32 s62, 0
L_x_41:
  buffer_load_dwordx4 v[56:59], v78, s[32:35], 0 offen sc1
  buffer_load_dwordx4 v[60:63], v78, s[32:35], s59 offen sc1
  s_waitcnt vmcnt(1)
  v_xor_b32 v48, s48, v56
  v_xor_b32 v49, s49, v57
  v_xor_b32 v50, s50, v58
  v_xor_b32 v51, s51, v59
  v_or_b32 v64, v48, v49
  v_or3_b32 v64, v50, v51, v64
  s_waitcnt vmcnt(0)
  v_xor_b32 v52, s48, v60
  v_xor_b32 v53, s49, v61
  v_xor_b32 v54, s50, v62
  v_xor_b32 v55, s51, v63
  v_or3_b32 v64, v52, v53, v64
  v_or3_b32 v64, v54, v55, v64
  v_cmp_ne_u32_sdwa vcc, v64, 0 src0_sel:BYTE_0 src1_sel:DWORD
  v_pk_add_f32 v[48:49], v[48:49], v[52:53]
  v_pk_add_f32 v[50:51], v[50:51], v[54:55]
  s_cbranch_vccz L_x_a_42
  s_add_u32 s62, s62, 1
  s_sleep 1
  s_cmp_lt_u32 s62, 2097152
  s_cbranch_scc1 L_x_41
L_x_a_42:
L_x_d_44:
  s_nop 0
  v_permlane32_swap_b32 v48, v50
  v_permlane32_swap_b32 v49, v51
  v_add_f32 v48, v48, v50
  v_add_f32 v49, v49, v51
  s_nop 1
  v_permlane16_swap_b32 v48, v49
  v_add_f32 v48, v48, v49
  v_cvt_pk_bf16_f32 v48, v48, v48
  v_lshlrev_b32 v48, 16, v48
  v_mul_f32 v48, v72, v48
  v_cvt_pk_bf16_f32 v48, v48, v48
  v_lshlrev_b32 v48, 16, v48
  v_add_f32 v48, v77, v48
  v_cvt_pk_bf16_f32 v48, v48, v48
  v_lshlrev_b32 v48, 16, v48
  v_sub_f32 v70, v48, v71
  v_mul_f32 v79, v70, v74
  v_mul_f32 v69, v70, v70
  v_mul_f32_dpp v73, v70, v75 quad_perm:[1,0,3,2] row_mask:0xf bank_mask:0xf
  v_add_f32_dpp v68, v70, v70 quad_perm:[1,0,3,2] row_mask:0xf bank_mask:0xf
  v_cvt_pk_bf16_f32 v79, v79, v73
  v_add_f32_dpp v69, v69, v69 quad_perm:[1,0,3,2] row_mask:0xf bank_mask:0xf
  s_nop 0
  v_mov_b32_dpp v120, v79 row_newbcast:0 row_mask:0xf bank_mask:0x3
  v_mov_b32_dpp v121, v79 row_newbcast:2 row_mask:0xf bank_mask:0x3
  v_mov_b32_dpp v122, v79 row_newbcast:4 row_mask:0xf bank_mask:0x3
  v_mov_b32_dpp v123, v79 row_newbcast:6 row_mask:0xf bank_mask:0x3
  v_mov_b32_dpp v120, v79 row_newbcast:8 row_mask:0xf bank_mask:0xc
  v_mov_b32_dpp v121, v79 row_newbcast:10 row_mask:0xf bank_mask:0xc
  v_mov_b32_dpp v122, v79 row_newbcast:12 row_mask:0xf bank_mask:0xc
  v_mov_b32_dpp v123, v79 row_newbcast:14 row_mask:0xf bank_mask:0xc
  s_nop 1
  v_mfma_f32_16x16x32_bf16 v[8:11], v[120:123], v[84:87], 0
  v_add_f32_dpp v68, v68, v68 quad_perm:[2,3,0,1] row_mask:0xf bank_mask:0xf
  v_add_f32_dpp v69, v69, v69 quad_perm:[2,3,0,1] row_mask:0xf bank_mask:0xf
  v_mfma_f32_16x16x32_bf16 v[24:27], v[120:123], v[100:103], 0
  v_add_f32_dpp v68, v68, v68 row_half_mirror row_mask:0xf bank_mask:0xf
  v_add_f32_dpp v69, v69, v69 row_half_mirror row_mask:0xf bank_mask:0xf
  v_mfma_f32_16x16x32_bf16 v[12:15], v[120:123], v[88:91], 0
  v_add_f32_dpp v68, v68, v68 row_mirror row_mask:0xf bank_mask:0xf
  v_add_f32_dpp v69, v69, v69 row_mirror row_mask:0xf bank_mask:0xf
  v_mfma_f32_16x16x32_bf16 v[28:31], v[120:123], v[104:107], 0
  s_nop 1
  v_mfma_f32_16x16x32_bf16 v[16:19], v[120:123], v[92:95], 0
  v_permlane32_swap_b32 v68, v69
  v_add_f32 v68, v68, v69
  v_mfma_f32_16x16x32_bf16 v[32:35], v[120:123], v[108:111], 0
  v_mov_b32 v69, v68
  s_nop 0
  v_mfma_f32_16x16x32_bf16 v[20:23], v[120:123], v[96:99], 0
  v_permlane16_swap_b32 v68, v69
  v_add_f32 v68, v68, v69
  v_mfma_f32_16x16x32_bf16 v[36:39], v[120:123], v[112:115], 0
  s_mov_b64 exec, s[42:43]
  ds_write_b32 v3, v68 offset:8192
  s_mov_b64 exec, -1
  v_cndmask_b32 v40, v8, v24, s[44:45]
  v_cndmask_b32 v41, v12, v28, s[44:45]
  v_cndmask_b32 v42, v16, v32, s[44:45]
  s_nop 1
  v_cndmask_b32 v43, v20, v36, s[44:45]
  s_mov_b64 exec, s[60:61]
  ds_write_b128 v76, v[40:43] offset:4096
  s_mov_b64 exec, -1
  s_waitcnt lgkmcnt(0)
  s_barrier
  s_endpgm
L_w0:
  s_setprio 3
  s_waitcnt lgkmcnt(0)
  s_load_dword s52, s[30:31], 0
  s_mov_b32 s32, s30
  s_mov_b32 s33, s31
  s_mov_b32 s34, 4194304
  s_mov_b32 s35, 0x20000
  s_mov_b32 s63, 2097152
  s_waitcnt lgkmcnt(0)
  s_add_u32 s52, s52, 1
  s_mul_i32 s55, s52, 0x9E3779B1
  s_and_b32 s48, s52, 0x7f
  s_bfe_u32 s49, s55, 458760
  s_bfe_u32 s50, s55, 458768
  s_bfe_u32 s51, s55, 458776
  s_bitset1_b32 s48, 7
  s_bitset1_b32 s49, 7
  s_bitset1_b32 s50, 7
  s_bitset1_b32 s51, 7
  s_and_b32 s6, s48, 15
  s_and_b32 s7, s49, 15
  s_and_b32 s8, s50, 15
  s_and_b32 s9, s51, 15
L_w0_q:
  v_mov_b32 v8, 0
  v_mov_b32 v9, 0
  v_lshlrev_b32 v3, 3, v0
  ds_write_b64 v3, v[8:9] offset:7680
  ds_write_b64 v3, v[8:9] offset:15872
  ds_write_b64 v3, v[8:9] offset:19968
  v_lshlrev_b32 v4, 4, v0
  s_lshl_b32 s55, s53, 15
  s_and_b32 s56, s54, 1
  s_lshl_b32 s56, s56, 11
  s_add_u32 s55, s55, s56
  s_lshr_b32 s56, s54, 1
  s_lshl_b32 s56, s56, 9
  s_add_u32 s55, s55, s56
  s_add_u32 s55, s55, 1572864
  v_and_b32 v3, 31, v0
  v_lshl_add_u32 v3, v3, 4, s55
  v_lshrrev_b32 v5, 5, v0
  v_lshl_add_u32 v3, v5, 12, v3
  s_mov_b32 s42, 8192
  s_mov_b32 s43, 16384
  s_mov_b32 s44, 24576
  v_mov_b32 v5, 0xfffffff0
  s_mov_b32 s60, -1
  s_mov_b32 s61, 0
  s_waitcnt lgkmcnt(0)
  s_barrier
  s_barrier
  ds_read_b128 v[8:11], v4 offset:4096
  ds_read_b128 v[12:15], v4 offset:5120
  ds_read_b128 v[16:19], v4 offset:6144
  ds_read_b128 v[20:23], v4 offset:7168
  s_waitcnt lgkmcnt(2)
  v_pk_add_f32 v[8:9], v[8:9], v[12:13]
  v_pk_add_f32 v[10:11], v[10:11], v[14:15]
  s_waitcnt lgkmcnt(0)
  v_pk_add_f32 v[16:17], v[16:17], v[20:21]
  v_pk_add_f32 v[18:19], v[18:19], v[22:23]
  v_pk_add_f32 v[8:9], v[8:9], v[16:17]
  v_pk_add_f32 v[10:11], v[10:11], v[18:19]
  v_mov_b32 v12, v8
  v_mov_b32 v13, v9
  v_mov_b32 v14, v10
  v_mov_b32 v15, v11
  v_permlane32_swap_b32 v8, v12
  v_permlane32_swap_b32 v9, v13
  v_permlane32_swap_b32 v10, v14
  v_permlane32_swap_b32 v11, v15
  v_pk_add_f32 v[8:9], v[8:9], v[12:13]
  v_pk_add_f32 v[10:11], v[10:11], v[14:15]
  v_add_u32 v8, 8, v8
  v_add_u32 v9, 8, v9
  v_add_u32 v10, 8, v10
  v_add_u32 v11, 8, v11
  v_and_or_b32 v8, v8, v5, s6
  v_and_or_b32 v9, v9, v5, s7
  v_and_or_b32 v10, v10, v5, s8
  v_and_or_b32 v11, v11, v5, s9
  buffer_store_dwordx4 v[8:11], v3, s[32:35], 0 offen
  s_mov_b64 exec, s[60:61]
  buffer_store_dwordx4 v[8:11], v3, s[32:35], s63 offen sc1
  s_mov_b64 exec, -1
  s_lshl_b32 s58, s53, 3
  s_mul_i32 s55, s53, 6
  s_add_u32 s55, s55, 8
  s_cmp_lt_u32 s53, 4
  s_cselect_b32 s58, s58, s55
  s_cselect_b32 s55, 8, 6
  s_add_u32 s58, s58, s54
  s_cmp_lt_u32 s54, s55
  s_cselect_b32 s58, s58, 56
  s_cmp_ge_u32 s58, 56
  s_cbranch_scc1 L_done
  s_and_b32 s55, s58, 6
  s_cmp_eq_u32 s55, 6
  s_cbranch_scc1 L_nohint
  s_lshl_b32 s55, s53, 8
  s_add_u32 s55, s55, 327680
  v_mov_b32 v12, s55
  s_mov_b32 s62, 0
L_hint_45:
  buffer_load_dword v13, v12, s[32:35], 0 offen sc1
  s_add_u32 s62, s62, 1
  s_waitcnt vmcnt(0)
  v_readfirstlane_b32 s55, v13
  s_cmp_eq_u32 s55, s52
  s_cbranch_scc1 L_hint_ok_46
  s_cmp_lt_u32 s62, 128
  s_cbranch_scc1 L_hint_45
L_hint_ok_46:
L_nohint:
  s_barrier
  s_endpgm
L_att2:
  v_mov_b32 v7, 0
  v_mov_b32 v112, 1
  s_mov_b64 exec, 1
  ds_add_rtn_u32 v96, v7, v112 offset:4
  s_mov_b64 exec, -1
  s_load_dword s52, s[30:31], 0
  s_mov_b32 s32, s30
  s_mov_b32 s33, s31
  s_mov_b32 s34, 4194304
  s_mov_b32 s35, 0x20000
  s_mov_b32 s63, 2097152
  s_waitcnt lgkmcnt(0)
  s_add_u32 s52, s52, 1
  s_mul_i32 s55, s52, 0x9E3779B1
  s_and_b32 s48, s52, 0x7f
  s_bfe_u32 s49, s55, 458760
  s_bfe_u32 s50, s55, 458768
  s_bfe_u32 s51, s55, 458776
  s_bitset1_b32 s48, 7
  s_bitset1_b32 s49, 7
  s_bitset1_b32 s50, 7
  s_bitset1_b32 s51, 7
  v_readfirstlane_b32 s55, v96
  s_cmp_lg_u32 s54, 10
  s_cbranch_scc1 L_att_nohint
  s_cmp_eq_u32 s55, 1
  s_cselect_b32 s56, 327680, 0
  s_cmp_eq_u32 s55, 99
  s_cselect_b32 s56, 327808, s56
  s_cmp_eq_u32 s56, 0
  s_cbranch_scc1 L_att_nohint
  s_lshl_b32 s55, s53, 8
  s_add_u32 s55, s55, s56
  v_mov_b32 v96, s55
  v_mov_b32 v97, s52
  s_mov_b64 exec, 1
  buffer_store_dword v97, v96, s[32:35], 0 offen
  s_mov_b64 exec, -1
L_att_nohint:
  v_and_b32 v96, 1, v0
  v_lshlrev_b32 v96, 4, v96
  v_mov_b32 v100, 0xffff
  v_lshlrev_b32 v96, v96, v100
  v_bfe_u32 v97, v0, 1, 2
  v_cmp_eq_u32 vcc, 0, v97
  s_nop 1
  v_cndmask_b32 v100, 0, v96, vcc
  v_cmp_eq_u32 vcc, 1, v97
  s_nop 1
  v_cndmask_b32 v101, 0, v96, vcc
  v_cmp_eq_u32 vcc, 2, v97
  s_nop 1
  v_cndmask_b32 v102, 0, v96, vcc
  v_cmp_eq_u32 vcc, 3, v97
  s_nop 1
  v_cndmask_b32 v103, 0, v96, vcc
  v_bfe_u32 v96, v0, 3, 1
  v_lshlrev_b32 v3, 9, v96
  v_lshl_add_u32 v3, v2, 6, v3
  v_and_b32 v4, 3, v0
  v_lshl_add_u32 v3, v4, 4, v3
  v_lshlrev_b32 v4, 6, v96
  s_lshl_b32 s56, s3, 2
  v_add_u32 v4, s56, v4
  s_lshl_b32 s56, s3, 11
  v_lshl_add_u32 v5, v0, 4, s56
  s_mov_b32 s56, 1035512379
  s_mov_b32 s62, 0
L_wq_1:
  ds_read_b32 v96, v7 offset:0
  ds_read_b128 v[72:75], v3 offset:1024
  ds_read_b128 v[76:79], v3 offset:1280
  s_add_u32 s62, s62, 1
  s_waitcnt lgkmcnt(0)
  v_readfirstlane_b32 s55, v96
  s_cmp_lg_u32 s55, 0
  s_cbranch_scc1 L_wq_ok_2
  s_sleep 1
  s_cmp_lt_u32 s62, 8388608
  s_cbranch_scc1 L_wq_1
L_wq_ok_2:
  s_waitcnt vmcnt(8)
  v_mfma_f32_16x16x32_bf16 v[80:83], v[8:11], v[72:75], 0
  v_mfma_f32_16x16x32_bf16 v[84:87], v[16:19], v[72:75], 0
  v_mfma_f32_16x16x32_bf16 v[88:91], v[24:27], v[72:75], 0
  v_mfma_f32_16x16x32_bf16 v[92:95], v[32:35], v[72:75], 0
  v_mfma_f32_16x16x32_bf16 v[80:83], v[12:15], v[76:79], v[80:83]
  v_mfma_f32_16x16x32_bf16 v[84:87], v[20:23], v[76:79], v[84:87]
  v_mfma_f32_16x16x32_bf16 v[88:91], v[28:31], v[76:79], v[88:91]
  v_mfma_f32_16x16x32_bf16 v[92:95], v[36:39], v[76:79], v[92:95]
  s_nop 4
  v_mov_b32_dpp v96, v80 quad_perm:[0,0,0,0] row_mask:0xf bank_mask:0x5
  s_nop 1
  v_mov_b32_dpp v96, v84 quad_perm:[0,0,0,0] row_mask:0xf bank_mask:0xa
  v_mov_b32_dpp v97, v88 quad_perm:[0,0,0,0] row_mask:0xf bank_mask:0x5
  s_nop 1
  v_mov_b32_dpp v97, v92 quad_perm:[0,0,0,0] row_mask:0xf bank_mask:0xa
  v_add_f32_dpp v96, v81, v96 quad_perm:[1,1,1,1] row_mask:0xf bank_mask:0x5
  s_nop 0
  v_add_f32_dpp v97, v89, v97 quad_perm:[1,1,1,1] row_mask:0xf bank_mask:0x5
  v_add_f32_dpp v96, v85, v96 quad_perm:[1,1,1,1] row_mask:0xf bank_mask:0xa
  s_nop 0
  v_add_f32_dpp v97, v93, v97 quad_perm:[1,1,1,1] row_mask:0xf bank_mask:0xa
  v_add_f32_dpp v96, v82, v96 quad_perm:[2,2,2,2] row_mask:0xf bank_mask:0x5
  s_nop 0
  v_add_f32_dpp v97, v90, v97 quad_perm:[2,2,2,2] row_mask:0xf bank_mask:0x5
  v_add_f32_dpp v96, v86, v96 quad_perm:[2,2,2,2] row_mask:0xf bank_mask:0xa
  s_nop 0
  v_add_f32_dpp v97, v94, v97 quad_perm:[2,2,2,2] row_mask:0xf bank_mask:0xa
  v_add_f32_dpp v96, v83, v96 quad_perm:[3,3,3,3] row_mask:0xf bank_mask:0x5
  s_nop 0
  v_add_f32_dpp v97, v91, v97 quad_perm:[3,3,3,3] row_mask:0xf bank_mask:0x5
  v_add_f32_dpp v96, v87, v96 quad_perm:[3,3,3,3] row_mask:0xf bank_mask:0xa
  s_nop 0
  v_add_f32_dpp v97, v95, v97 quad_perm:[3,3,3,3] row_mask:0xf bank_mask:0xa
  v_cvt_pk_bf16_f32 v80, v96, v97
  v_lshlrev_b32 v96, 16, v80
  v_and_b32 v97, 0xffff0000, v80
  s_cmp_lt_u32 s57, 0x200000
  s_cbranch_scc1 L_att_inb
  v_mov_b32 v96, 4286513152
  v_mov_b32 v97, 4286513152
L_att_inb:
  v_max_f32 v82, v96, v97
  s_nop 1
  v_max_f32_dpp v82, v82, v82 row_half_mirror row_mask:0xf bank_mask:0xf
  v_mov_b32 v80, v82
  s_nop 1
  v_permlane16_swap_b32 v82, v80
  v_max_f32 v82, v82, v80
  v_mov_b32 v80, v82
  s_nop 1
  v_permlane32_swap_b32 v82, v80
  v_max_f32 v82, v82, v80
  v_pk_add_f32 v[96:97], v[96:97], v[82:83] op_sel:[0,0] op_sel_hi:[1,0] neg_lo:[0,1] neg_hi:[0,1]
  v_mul_f32 v96, s56, v96
  v_mul_f32 v97, s56, v97
  v_exp_f32 v96, v96
  v_exp_f32 v97, v97
  s_nop 0
  v_add_f32 v83, v96, v97
  v_cvt_pk_bf16_f32 v96, v96, v96
  v_cvt_pk_bf16_f32 v97, v97, v97
  v_add_f32_dpp v83, v83, v83 row_half_mirror row_mask:0xf bank_mask:0xf
  v_mov_b32 v80, v83
  v_and_b32 v8, v100, v96
  v_and_b32 v9, v101, v96
  v_and_b32_dpp v10, v96, v102 row_half_mirror row_mask:0xf bank_mask:0xf
  v_and_b32_dpp v11, v96, v103 row_half_mirror row_mask:0xf bank_mask:0xf
  v_permlane16_swap_b32 v83, v80
  v_add_f32 v83, v83, v80
  v_mov_b32 v80, v83
  v_and_b32_dpp v12, v96, v100 row_half_mirror row_mask:0xf bank_mask:0xf
  v_and_b32_dpp v13, v96, v101 row_half_mirror row_mask:0xf bank_mask:0xf
  v_and_b32 v14, v102, v96
  v_and_b32 v15, v103, v96
  v_permlane32_swap_b32 v83, v80
  v_add_f32 v83, v83, v80
  s_mov_b64 exec, 0x101
  ds_write_b32 v4, v82 offset:64
  ds_write_b32 v4, v83 offset:192
  s_mov_b64 exec, 1
  ds_add_u32 v7, v112 offset:16
  s_mov_b64 exec, -1
  v_and_b32 v16, v100, v97
  v_and_b32 v17, v101, v97
  v_and_b32_dpp v18, v97, v102 row_half_mirror row_mask:0xf bank_mask:0xf
  v_and_b32_dpp v19, v97, v103 row_half_mirror row_mask:0xf bank_mask:0xf
  v_and_b32_dpp v20, v97, v100 row_half_mirror row_mask:0xf bank_mask:0xf
  v_and_b32_dpp v21, v97, v101 row_half_mirror row_mask:0xf bank_mask:0xf
  v_and_b32 v22, v102, v97
  v_and_b32 v23, v103, v97
  s_waitcnt vmcnt(7)
  v_mfma_f32_16x16x32_bf16 v[104:107], v[8:11], v[40:43], 0
  s_waitcnt vmcnt(6)
  v_mfma_f32_16x16x32_bf16 v[108:111], v[8:11], v[44:47], 0
  s_waitcnt vmcnt(5)
  v_mfma_f32_16x16x32_bf16 v[104:107], v[12:15], v[48:51], v[104:107]
  s_waitcnt vmcnt(4)
  v_mfma_f32_16x16x32_bf16 v[108:111], v[12:15], v[52:55], v[108:111]
  s_waitcnt vmcnt(3)
  v_mfma_f32_16x16x32_bf16 v[104:107], v[16:19], v[56:59], v[104:107]
  s_waitcnt vmcnt(2)
  v_mfma_f32_16x16x32_bf16 v[108:111], v[16:19], v[60:63], v[108:111]
  s_waitcnt vmcnt(1)
  v_mfma_f32_16x16x32_bf16 v[104:107], v[20:23], v[64:67], v[104:107]
  s_waitcnt vmcnt(0)
  v_mfma_f32_16x16x32_bf16 v[108:111], v[20:23], v[68:71], v[108:111]
  s_nop 5
  ds_write_b128 v5, v[104:107] offset:2048
  s_nop 0
  ds_write_b128 v5, v[108:111] offset:3072
  s_waitcnt lgkmcnt(0)
  s_barrier
  s_cmp_lg_u32 s3, 0
  s_cbranch_scc1 L_done
  s_cmp_ge_u32 s54, 14
  s_cbranch_scc1 L_done
  s_setprio 3
  v_and_b32 v1, 7, v0
  v_lshrrev_b32 v2, 3, v0
  s_lshl_b32 s55, s54, 7
  v_lshl_add_u32 v3, v1, 4, s55
  s_lshl_b32 s55, s53, 16
  s_add_u32 s55, s55, 1048576
  v_lshl_add_u32 v4, v2, 11, v3
  v_add_u32 v4, s55, v4
  s_mul_i32 s55, s53, 1792
  s_add_u32 s55, s55, 393216
  v_add_u32 v3, s55, v3
  v_lshl_add_u32 v3, v2, 14, v3
  s_mov_b32 s58, 16384
  s_mov_b32 s59, 32768
  v_mov_b32 v5, 0xffffff00
  s_mov_b32 s60, -1
  s_mov_b32 s61, 0xffff
  v_mov_b32 v24, s48
  v_mov_b32 v25, s49
  v_mov_b32 v26, s50
  v_mov_b32 v27, s51
  v_mov_b32 v36, s48
  v_mov_b32 v37, s49
  v_mov_b32 v38, s50
  v_mov_b32 v39, s51
  s_mov_b32 s62, 0
L_r_w3_3:
  ds_read_b32 v6, v7 offset:28
  s_add_u32 s62, s62, 1
  s_waitcnt lgkmcnt(0)
  v_readfirstlane_b32 s55, v6
  s_cmp_ge_u32 s55, 2
  s_cbranch_scc1 L_r_w3_ok_4
  s_cmp_lt_u32 s62, 8388608
  s_cbranch_scc1 L_r_w3_3
L_r_w3_ok_4:
  s_mov_b32 s62, 0
L_r_5:
  buffer_load_dwordx4 v[16:19], v4, s[32:35], 0 offen sc1
  buffer_load_dwordx4 v[20:23], v4, s[32:35], s58 offen sc1
  s_mov_b64 exec, s[60:61]
  buffer_load_dwordx4 v[24:27], v4, s[32:35], s59 offen sc1
  s_mov_b64 exec, -1
  s_waitcnt vmcnt(2)
  v_xor_b32 v40, s48, v16
  v_xor_b32 v41, s49, v17
  v_xor_b32 v42, s50, v18
  v_xor_b32 v43, s51, v19
  v_or_b32 v6, v40, v41
  v_or3_b32 v6, v42, v43, v6
  s_waitcnt vmcnt(1)
  v_xor_b32 v44, s48, v20
  v_xor_b32 v45, s49, v21
  v_xor_b32 v46, s50, v22
  v_xor_b32 v47, s51, v23
  v_or3_b32 v6, v44, v45, v6
  v_or3_b32 v6, v46, v47, v6
  v_pk_add_f32 v[40:41], v[40:41], v[44:45]
  v_pk_add_f32 v[42:43], v[42:43], v[46:47]
  s_waitcnt vmcnt(0)
  v_xor_b32 v48, s48, v24
  v_xor_b32 v49, s49, v25
  v_xor_b32 v50, s50, v26
  v_xor_b32 v51, s51, v27
  v_or3_b32 v6, v48, v49, v6
  v_or3_b32 v6, v50, v51, v6
  v_cmp_ne_u32_sdwa vcc, v6, 0 src0_sel:BYTE_0 src1_sel:DWORD
  v_pk_add_f32 v[40:41], v[40:41], v[48:49]
  v_pk_add_f32 v[42:43], v[42:43], v[50:51]
  s_cbranch_vccz L_r_a_6
  s_add_u32 s62, s62, 1
  s_cmp_lt_u32 s62, 512
  s_cbranch_scc1 L_r_nf_9
  s_mov_b64 exec, -1
  v_xor_b32 v4, s63, v4
L_r_nf_9:
  s_cmp_lt_u32 s62, 2097152
  s_cbranch_scc1 L_r_5
L_r_a_6:
L_r_d_8:
  s_nop 0
  v_permlane32_swap_b32 v40, v42
  v_permlane32_swap_b32 v41, v43
  v_add_f32 v40, v40, v42
  v_add_f32 v41, v41, v43
  s_nop 1
  v_permlane16_swap_b32 v40, v41
  v_add_f32 v40, v40, v41
  s_nop 1
  v_add_f32_dpp v40, v40, v40 row_ror:8 row_mask:0xf bank_mask:0xf
  v_mov_b32 v41, v40
  s_nop 1
  v_permlane16_swap_b32 v40, v41
  v_mov_b32 v42, v40
  v_mov_b32 v43, v41
  s_nop 0
  v_permlane32_swap_b32 v40, v42
  v_permlane32_swap_b32 v41, v43
  v_and_or_b32 v44, v40, v5, s48
  v_and_or_b32 v45, v41, v5, s49
  v_and_or_b32 v46, v42, v5, s50
  v_and_or_b32 v47, v43, v5, s51
  buffer_store_dwordx4 v[44:47], v3, s[32:35], 0 offen sc1
  s_endpgm
L_attw2:
  s_setprio 3
  s_waitcnt lgkmcnt(0)
  s_load_dword s52, s[30:31], 0
  s_mov_b32 s32, s30
  s_mov_b32 s33, s31
  s_mov_b32 s34, 4194304
  s_mov_b32 s35, 0x20000
  s_mov_b32 s63, 2097152
  s_waitcnt lgkmcnt(0)
  s_add_u32 s52, s52, 1
  s_mul_i32 s55, s52, 0x9E3779B1
  s_and_b32 s48, s52, 0x7f
  s_bfe_u32 s49, s55, 458760
  s_bfe_u32 s50, s55, 458768
  s_bfe_u32 s51, s55, 458776
  s_bitset1_b32 s48, 7
  s_bitset1_b32 s49, 7
  s_bitset1_b32 s50, 7
  s_bitset1_b32 s51, 7
  s_mul_i32 s56, s53, 458752
  s_add_u32 s36, s12, s56
  s_addc_u32 s37, s13, 0
  s_mov_b32 s38, 458752
  s_mov_b32 s39, 0x20000
  s_mul_i32 s56, s54, 21504
  s_and_b32 s55, s57, 1
  s_lshl_b32 s55, s55, 9
  s_add_u32 s56, s56, s55
  v_mul_u32_u24 v3, 896, v2
  v_lshl_add_u32 v3, v1, 4, v3
  v_add_u32 v3, s56, v3
  v_add_u32 v4, 7168, v3
  v_add_u32 v5, 14336, v3
  v_and_b32 v60, 1, v0
  v_lshlrev_b32 v60, 4, v60
  v_mov_b32 v56, 0xffff
  v_lshlrev_b32 v60, v60, v56
  v_bfe_u32 v61, v0, 1, 2
  v_cmp_eq_u32 vcc, 0, v61
  s_nop 1
  v_cndmask_b32 v56, 0, v60, vcc
  v_cmp_eq_u32 vcc, 1, v61
  s_nop 1
  v_cndmask_b32 v57, 0, v60, vcc
  v_cmp_eq_u32 vcc, 2, v61
  s_nop 1
  v_cndmask_b32 v58, 0, v60, vcc
  v_cmp_eq_u32 vcc, 3, v61
  s_nop 1
  v_cndmask_b32 v59, 0, v60, vcc
  v_mov_b32 v63, 1
  s_cmp_ge_u32 s57, 2
  s_cbranch_scc1 L_attw_wf2
  s_lshl_b32 s55, s53, 15
  s_add_u32 s55, s55, 1572864
  s_mul_i32 s18, s57, 0
  v_lshl_add_u32 v6, v0, 4, s55
  v_lshlrev_b32 v60, 3, v0
  s_and_b32 s6, s48, 15
  s_and_b32 s7, s49, 15
  s_and_b32 s8, s50, 15
  s_and_b32 s9, s51, 15
  s_mov_b32 s62, 0
L_qg_10:
  ds_read_b32 v61, v7 offset:4
  s_add_u32 s62, s62, 1
  s_waitcnt lgkmcnt(0)
  v_readfirstlane_b32 s55, v61
  s_cmp_ge_u32 s55, 2
  s_cbranch_scc1 L_qg_ok_11
  s_sleep 2
  s_cmp_lt_u32 s62, 8388608
  s_cbranch_scc1 L_qg_10
L_qg_ok_11:
  s_cmp_eq_u32 s57, 0
  s_cbranch_scc1 L_qp_start
  s_sleep 20
L_qp_start:
  s_mov_b32 s62, 0
L_qp:
  buffer_load_dwordx4 v[64:67], v6, s[32:35], s18 offen sc1
  buffer_load_dwordx4 v[68:71], v6, s[32:35], s18 offen offset:1024 sc1
  buffer_load_dwordx4 v[72:75], v6, s[32:35], s18 offen offset:2048 sc1
  buffer_load_dwordx4 v[76:79], v6, s[32:35], s18 offen offset:3072 sc1
  s_waitcnt vmcnt(0)
  ds_read_b32 v62, v7 offset:0
  v_xor_b32 v64, s6, v64
  v_xor_b32 v65, s7, v65
  v_xor_b32 v66, s8, v66
  v_xor_b32 v67, s9, v67
  v_or_b32 v61, v64, v65
  v_or3_b32 v61, v66, v67, v61
  v_xor_b32 v68, s6, v68
  v_xor_b32 v69, s7, v69
  v_xor_b32 v70, s8, v70
  v_xor_b32 v71, s9, v71
  v_or3_b32 v61, v68, v69, v61
  v_or3_b32 v61, v70, v71, v61
  v_xor_b32 v72, s6, v72
  v_xor_b32 v73, s7, v73
  v_xor_b32 v74, s8, v74
  v_xor_b32 v75, s9, v75
  v_or3_b32 v61, v72, v73, v61
  v_or3_b32 v61, v74, v75, v61
  v_xor_b32 v76, s6, v76
  v_xor_b32 v77, s7, v77
  v_xor_b32 v78, s8, v78
  v_xor_b32 v79, s9, v79
  v_or3_b32 v61, v76, v77, v61
  v_or3_b32 v61, v78, v79, v61
  v_and_b32 v61, 15, v61
  v_cmp_ne_u32 vcc, 0, v61
  s_cbranch_vccz L_qp_ok
  s_waitcnt lgkmcnt(0)
  v_readfirstlane_b32 s55, v62
  s_cmp_lg_u32 s55, 0
  s_cbranch_scc1 L_attw_wf2
  s_add_u32 s62, s62, 1
  s_cmp_lt_u32 s62, 512
  s_cbranch_scc1 L_qp_nf
  v_xor_b32 v6, s63, v6
  s_mov_b32 s18, 0
L_qp_nf:
  s_cmp_lt_u32 s62, 2097152
  s_cbranch_scc1 L_qp
L_qp_ok:
  v_pk_add_f32 v[64:65], v[64:65], v[72:73]
  v_pk_add_f32 v[66:67], v[66:67], v[74:75]
  v_pk_add_f32 v[68:69], v[68:69], v[76:77]
  v_pk_add_f32 v[70:71], v[70:71], v[78:79]
  v_cvt_pk_bf16_f32 v64, v64, v65
  v_cvt_pk_bf16_f32 v65, v66, v67
  v_cvt_pk_bf16_f32 v66, v68, v69
  v_cvt_pk_bf16_f32 v67, v70, v71
  ds_write_b64 v60, v[64:65] offset:1024
  ds_write_b64 v60, v[66:67] offset:1536
  ds_write_b32 v7, v63 offset:0
L_attw_wf2:
  s_lshl_b32 s59, s53, 16
  s_lshl_b32 s56, s54, 11
  s_add_u32 s56, s56, s59
  s_cmp_lt_u32 s57, 2
  s_cbranch_scc1 L_attw_nowo
  s_and_b32 s58, s57, 1
  s_lshl_b32 s58, s58, 10
  s_add_u32 s58, s58, s56
  s_add_u32 s58, s58, 1048576
  s_add_u32 s55, s56, 1048576
  v_lshl_add_u32 v61, v0, 7, s55
  s_mov_b32 s60, -1
  s_cmp_eq_u32 s57, 3
  s_cselect_b32 s60, 0x00ff00ff, s60
  s_mov_b32 s61, s60
  s_mov_b32 s62, 0
L_wf2_12:
  ds_read_b32 v62, v7 offset:4
  s_add_u32 s62, s62, 1
  s_waitcnt lgkmcnt(0)
  v_readfirstlane_b32 s55, v62
  s_cmp_ge_u32 s55, 12
  s_cbranch_scc1 L_wf2_ok_13
  s_sleep 2
  s_cmp_lt_u32 s62, 8388608
  s_cbranch_scc1 L_wf2_12
L_wf2_ok_13:
  s_cmp_lg_u32 s57, 3
  s_cbranch_scc1 L_attw_nopr
  s_mov_b64 exec, 0x3fff
  buffer_load_dword v124, v61, s[32:35], 0 offen sc1
  s_mov_b64 exec, -1
L_attw_nopr:
  buffer_load_dwordx4 v[8:11], v3, s[36:39], 0 offen offset:0 nt
  buffer_load_dwordx4 v[12:15], v3, s[36:39], 0 offen offset:3584 nt
  buffer_load_dwordx4 v[16:19], v4, s[36:39], 0 offen offset:0 nt
  buffer_load_dwordx4 v[20:23], v4, s[36:39], 0 offen offset:3584 nt
  buffer_load_dwordx4 v[24:27], v5, s[36:39], 0 offen offset:0 nt
  buffer_load_dwordx4 v[28:31], v5, s[36:39], 0 offen offset:3584 nt
  s_mov_b64 exec, s[60:61]
  buffer_load_dwordx4 v[32:35], v3, s[36:39], 0 offen offset:256 nt
  buffer_load_dwordx4 v[36:39], v3, s[36:39], 0 offen offset:3840 nt
  buffer_load_dwordx4 v[40:43], v4, s[36:39], 0 offen offset:256 nt
  buffer_load_dwordx4 v[44:47], v4, s[36:39], 0 offen offset:3840 nt
  buffer_load_dwordx4 v[48:51], v5, s[36:39], 0 offen offset:256 nt
  buffer_load_dwordx4 v[52:55], v5, s[36:39], 0 offen offset:3840 nt
  s_mov_b64 exec, -1
  v_lshlrev_b32 v3, 5, v1
  v_lshl_add_u32 v3, v2, 4, v3
  v_add_u32 v3, s58, v3
L_attw_nowo:
  v_lshlrev_b32 v4, 5, v2
  v_mov_b32 v5, 0xffffff00
  s_cmp_eq_u32 s57, 0
  s_cbranch_scc1 L_h1
  v_lshlrev_b32 v6, 5, v2
  v_and_b32 v6, 0x40, v6
  s_mov_b32 s46, 1035512379
  s_cmp_eq_u32 s57, 3
  s_cbranch_scc1 L_cst_addr
  s_sub_u32 s55, s57, 1
  s_lshl_b32 s58, s55, 10
  v_lshl_add_u32 v60, v0, 4, s58
  v_lshrrev_b32 v61, 1, v2
  v_lshlrev_b32 v61, 10, v61
  v_and_b32 v62, 1, v2
  v_lshl_add_u32 v61, v62, 4, v61
  v_lshl_add_u32 v61, v1, 5, v61
  s_lshl_b32 s55, s55, 9
  s_add_u32 s55, s55, s56
  s_add_u32 s55, s55, 524288
  v_add_u32 v61, s55, v61
  s_mov_b64 s[44:45], -1
  s_branch L_cst_go
L_cst_addr:
  s_lshl_b32 s58, s54, 7
  s_add_u32 s58, s58, s59
  s_add_u32 s58, s58, 573440
  v_lshrrev_b32 v61, 2, v6
  v_add_u32 v61, s58, v61
  s_mov_b32 s44, 1
  s_mov_b32 s45, 1
L_cst_go:
  s_mov_b32 s62, 0
L_wst_14:
  ds_read_b32 v62, v7 offset:16
  s_add_u32 s62, s62, 1
  s_waitcnt lgkmcnt(0)
  v_readfirstlane_b32 s55, v62
  s_cmp_ge_u32 s55, 12
  s_cbranch_scc1 L_wst_ok_15
  s_sleep 1
  s_cmp_lt_u32 s62, 8388608
  s_cbranch_scc1 L_wst_14
L_wst_ok_15:
  ds_read_b128 v[64:67], v6 offset:64
  ds_read_b128 v[68:71], v6 offset:80
  ds_read_b128 v[72:75], v6 offset:96
  ds_read_b128 v[76:79], v6 offset:192
  ds_read_b128 v[80:83], v6 offset:208
  ds_read_b128 v[84:87], v6 offset:224
  s_waitcnt lgkmcnt(0)
  v_max3_f32 v88, v64, v65, v66
  v_max3_f32 v89, v67, v68, v69
  v_max3_f32 v88, v88, v70, v71
  v_max3_f32 v89, v89, v72, v73
  v_max3_f32 v88, v88, v74, v75
  v_max_f32 v88, v88, v89
  v_pk_add_f32 v[64:65], v[64:65], v[88:89] op_sel:[0,0] op_sel_hi:[1,0] neg_lo:[0,1] neg_hi:[0,1]
  v_pk_add_f32 v[66:67], v[66:67], v[88:89] op_sel:[0,0] op_sel_hi:[1,0] neg_lo:[0,1] neg_hi:[0,1]
  v_pk_add_f32 v[68:69], v[68:69], v[88:89] op_sel:[0,0] op_sel_hi:[1,0] neg_lo:[0,1] neg_hi:[0,1]
  v_pk_add_f32 v[70:71], v[70:71], v[88:89] op_sel:[0,0] op_sel_hi:[1,0] neg_lo:[0,1] neg_hi:[0,1]
  v_pk_add_f32 v[72:73], v[72:73], v[88:89] op_sel:[0,0] op_sel_hi:[1,0] neg_lo:[0,1] neg_hi:[0,1]
  v_pk_add_f32 v[74:75], v[74:75], v[88:89] op_sel:[0,0] op_sel_hi:[1,0] neg_lo:[0,1] neg_hi:[0,1]
  v_mul_f32 v64, s46, v64
  v_mul_f32 v65, s46, v65
  v_mul_f32 v66, s46, v66
  v_mul_f32 v67, s46, v67
  v_mul_f32 v68, s46, v68
  v_mul_f32 v69, s46, v69
  v_mul_f32 v70, s46, v70
  v_mul_f32 v71, s46, v71
  v_mul_f32 v72, s46, v72
  v_mul_f32 v73, s46, v73
  v_mul_f32 v74, s46, v74
  v_mul_f32 v75, s46, v75
  v_exp_f32 v64, v64
  v_exp_f32 v65, v65
  v_exp_f32 v66, v66
  v_exp_f32 v67, v67
  v_exp_f32 v68, v68
  v_exp_f32 v69, v69
  v_exp_f32 v70, v70
  v_exp_f32 v71, v71
  v_exp_f32 v72, v72
  v_exp_f32 v73, v73
  v_exp_f32 v74, v74
  v_exp_f32 v75, v75
  s_cmp_lg_u32 s57, 3
  s_cbranch_scc1 L_comb
  v_mul_f32 v89, v64, v76
  v_mul_f32 v90, v65, v77
  v_fmac_f32 v89, v66, v78
  v_fmac_f32 v90, v67, v79
  v_fmac_f32 v89, v68, v80
  v_fmac_f32 v90, v69, v81
  v_fmac_f32 v89, v70, v82
  v_fmac_f32 v90, v71, v83
  v_fmac_f32 v89, v72, v84
  v_fmac_f32 v90, v73, v85
  v_fmac_f32 v89, v74, v86
  v_fmac_f32 v90, v75, v87
  v_or_b32 v120, s48, v88
  v_add_f32 v89, v89, v90
  s_getreg_b32 s55, hwreg(HW_REG_XCC_ID, 0, 4)
  s_lshl_b32 s55, s55, 8
  s_or_b32 s55, s55, s50
  v_mov_b32 v122, s55
  v_mov_b32 v123, s51
  v_and_or_b32 v121, v89, v5, s49
  s_mov_b64 exec, s[44:45]
  buffer_store_dwordx4 v[120:123], v61, s[32:35], 0 offen
  s_mov_b64 exec, -1
  s_barrier
  s_branch L_attw_b2
L_comb:
  s_barrier
  ds_read_b128 v[76:79], v60 offset:2048
  ds_read_b128 v[80:83], v60 offset:4096
  ds_read_b128 v[84:87], v60 offset:6144
  ds_read_b128 v[88:91], v60 offset:8192
  ds_read_b128 v[92:95], v60 offset:10240
  ds_read_b128 v[96:99], v60 offset:12288
  ds_read_b128 v[100:103], v60 offset:14336
  ds_read_b128 v[104:107], v60 offset:16384
  ds_read_b128 v[108:111], v60 offset:18432
  ds_read_b128 v[112:115], v60 offset:20480
  ds_read_b128 v[116:119], v60 offset:22528
  ds_read_b128 v[124:127], v60 offset:24576
  s_waitcnt lgkmcnt(11)
  v_pk_mul_f32 v[120:121], v[76:77], v[64:65] op_sel:[0,0] op_sel_hi:[1,0]
  v_pk_mul_f32 v[122:123], v[78:79], v[64:65] op_sel:[0,0] op_sel_hi:[1,0]
  s_waitcnt lgkmcnt(10)
  v_pk_fma_f32 v[120:121], v[80:81], v[64:65], v[120:121] op_sel:[0,1,0] op_sel_hi:[1,1,1]
  v_pk_fma_f32 v[122:123], v[82:83], v[64:65], v[122:123] op_sel:[0,1,0] op_sel_hi:[1,1,1]
  s_waitcnt lgkmcnt(9)
  v_pk_fma_f32 v[120:121], v[84:85], v[66:67], v[120:121] op_sel:[0,0,0] op_sel_hi:[1,0,1]
  v_pk_fma_f32 v[122:123], v[86:87], v[66:67], v[122:123] op_sel:[0,0,0] op_sel_hi:[1,0,1]
  s_waitcnt lgkmcnt(8)
  v_pk_fma_f32 v[120:121], v[88:89], v[66:67], v[120:121] op_sel:[0,1,0] op_sel_hi:[1,1,1]
  v_pk_fma_f32 v[122:123], v[90:91], v[66:67], v[122:123] op_sel:[0,1,0] op_sel_hi:[1,1,1]
  s_waitcnt lgkmcnt(7)
  v_pk_fma_f32 v[120:121], v[92:93], v[68:69], v[120:121] op_sel:[0,0,0] op_sel_hi:[1,0,1]
  v_pk_fma_f32 v[122:123], v[94:95], v[68:69], v[122:123] op_sel:[0,0,0] op_sel_hi:[1,0,1]
  s_waitcnt lgkmcnt(6)
  v_pk_fma_f32 v[120:121], v[96:97], v[68:69], v[120:121] op_sel:[0,1,0] op_sel_hi:[1,1,1]
  v_pk_fma_f32 v[122:123], v[98:99], v[68:69], v[122:123] op_sel:[0,1,0] op_sel_hi:[1,1,1]
  s_waitcnt lgkmcnt(5)
  v_pk_fma_f32 v[120:121], v[100:101], v[70:71], v[120:121] op_sel:[0,0,0] op_sel_hi:[1,0,1]
  v_pk_fma_f32 v[122:123], v[102:103], v[70:71], v[122:123] op_sel:[0,0,0] op_sel_hi:[1,0,1]
  s_waitcnt lgkmcnt(4)
  v_pk_fma_f32 v[120:121], v[104:105], v[70:71], v[120:121] op_sel:[0,1,0] op_sel_hi:[1,1,1]
  v_pk_fma_f32 v[122:123], v[106:107], v[70:71], v[122:123] op_sel:[0,1,0] op_sel_hi:[1,1,1]
  s_waitcnt lgkmcnt(3)
  v_pk_fma_f32 v[120:121], v[108:109], v[72:73], v[120:121] op_sel:[0,0,0] op_sel_hi:[1,0,1]
  v_pk_fma_f32 v[122:123], v[110:111], v[72:73], v[122:123] op_sel:[0,0,0] op_sel_hi:[1,0,1]
  s_waitcnt lgkmcnt(2)
  v_pk_fma_f32 v[120:121], v[112:113], v[72:73], v[120:121] op_sel:[0,1,0] op_sel_hi:[1,1,1]
  v_pk_fma_f32 v[122:123], v[114:115], v[72:73], v[122:123] op_sel:[0,1,0] op_sel_hi:[1,1,1]
  s_waitcnt lgkmcnt(1)
  v_pk_fma_f32 v[120:121], v[116:117], v[74:75], v[120:121] op_sel:[0,0,0] op_sel_hi:[1,0,1]
  v_pk_fma_f32 v[122:123], v[118:119], v[74:75], v[122:123] op_sel:[0,0,0] op_sel_hi:[1,0,1]
  s_waitcnt lgkmcnt(0)
  v_pk_fma_f32 v[120:121], v[124:125], v[74:75], v[120:121] op_sel:[0,1,0] op_sel_hi:[1,1,1]
  v_pk_fma_f32 v[122:123], v[126:127], v[74:75], v[122:123] op_sel:[0,1,0] op_sel_hi:[1,1,1]
  v_and_or_b32 v120, v120, v5, s48
  v_and_or_b32 v121, v121, v5, s49
  v_and_or_b32 v122, v122, v5, s50
  v_and_or_b32 v123, v123, v5, s51
  buffer_store_dwordx4 v[120:123], v61, s[32:35], 0 offen
  s_branch L_attw_b2
L_h1:
  v_and_b32 v60, 7, v0
  v_lshrrev_b32 v61, 3, v0
  s_mul_i32 s56, s54, 6
  v_add_u32 v62, s56, v60
  s_add_u32 s55, s59, 524288
  v_lshlrev_b32 v112, 11, v61
  v_lshl_add_u32 v112, v62, 4, v112
  v_add_u32 v112, s55, v112
  v_lshrrev_b32 v6, 6, v62
  v_lshlrev_b32 v113, 7, v61
  v_lshl_add_u32 v113, v6, 4, v113
  s_add_u32 s55, s55, 49152
  v_add_u32 v113, s55, v113
  v_cmp_gt_u32 vcc, 6, v60
  s_movk_i32 s55, 128
  v_cmp_gt_u32 s[60:61], s55, v62
  s_and_b64 s[60:61], s[60:61], vcc
  s_mov_b32 s44, -1
  s_mov_b32 s45, 0xffff
  s_and_b64 s[44:45], s[44:45], s[60:61]
  s_mov_b32 s46, 0x00ff00ff
  s_mov_b32 s47, 0x00ff00ff
  s_and_b64 s[46:47], s[46:47], s[60:61]
  v_lshlrev_b32 v114, 5, v2
  v_lshl_add_u32 v114, v60, 2, v114
  s_mov_b32 s58, 16384
  s_mov_b32 s59, 32768
  s_mov_b32 s56, 1035512379
  s_getreg_b32 s43, hwreg(HW_REG_XCC_ID, 0, 4)
  s_lshl_b32 s43, s43, 8
  v_mov_b32 v72, s48
  v_mov_b32 v73, s49
  v_mov_b32 v74, s50
  v_mov_b32 v75, s51
  v_or_b32 v72, 4286513152, v72
  v_or_b32 v74, s43, v74
  v_mov_b32 v96, s48
  v_mov_b32 v97, s49
  v_mov_b32 v98, s50
  v_mov_b32 v99, s51
  v_mov_b32 v108, s48
  v_mov_b32 v109, s49
  v_mov_b32 v110, s50
  v_mov_b32 v111, s51
  s_barrier
  s_mov_b32 s62, 0
L_hs_16:
  s_mov_b64 exec, s[60:61]
  buffer_load_dwordx4 v[64:67], v113, s[32:35], 0 offen sc1
  buffer_load_dwordx4 v[68:71], v113, s[32:35], 0 offen offset:1024 sc1
  s_mov_b64 exec, s[44:45]
  buffer_load_dwordx4 v[72:75], v113, s[32:35], 0 offen offset:2048 sc1
  s_mov_b64 exec, s[60:61]
  buffer_load_dwordx4 v[88:91], v112, s[32:35], 0 offen sc1
  buffer_load_dwordx4 v[92:95], v112, s[32:35], s58 offen sc1
  s_mov_b64 exec, s[44:45]
  buffer_load_dwordx4 v[96:99], v112, s[32:35], s59 offen sc1
  s_mov_b64 exec, s[60:61]
  s_waitcnt vmcnt(5)
  v_xor_b32 v32, s48, v64
  v_xor_b32 v33, s49, v65
  v_xor_b32 v34, s50, v66
  v_xor_b32 v35, s51, v67
  v_or_b32 v115, v32, v33
  v_or3_b32 v115, v34, v35, v115
  s_waitcnt vmcnt(4)
  v_xor_b32 v36, s48, v68
  v_xor_b32 v37, s49, v69
  v_xor_b32 v38, s50, v70
  v_xor_b32 v39, s51, v71
  v_or3_b32 v115, v36, v37, v115
  v_or3_b32 v115, v38, v39, v115
  s_waitcnt vmcnt(3)
  v_xor_b32 v40, s48, v72
  v_xor_b32 v41, s49, v73
  v_xor_b32 v42, s50, v74
  v_xor_b32 v43, s51, v75
  v_or3_b32 v115, v40, v41, v115
  v_or3_b32 v115, v42, v43, v115
  v_cmp_ne_u32_sdwa vcc, v115, 0 src0_sel:BYTE_0 src1_sel:DWORD
  s_cbranch_vccz L_hs_a_17
  s_add_u32 s62, s62, 1
  s_cmp_lt_u32 s62, 512
  s_cbranch_scc1 L_hs_nf_20
  s_mov_b64 exec, -1
  v_xor_b32 v113, s63, v113
L_hs_nf_20:
  s_cmp_lt_u32 s62, 2097152
  s_cbranch_scc1 L_hs_16
L_hs_a_17:
  s_mov_b64 exec, -1
L_hs_d_19:
  v_max3_f32 v115, v32, v36, v40
  s_nop 1
  v_max_f32_dpp v115, v115, v115 row_ror:8 row_mask:0xf bank_mask:0xf
  v_mov_b32 v116, v115
  s_nop 1
  v_permlane16_swap_b32 v115, v116
  v_max_f32 v115, v115, v116
  v_mov_b32 v116, v115
  s_nop 1
  v_permlane32_swap_b32 v115, v116
  v_max_f32 v115, v115, v116
  v_sub_f32 v32, v32, v115
  v_sub_f32 v36, v36, v115
  v_sub_f32 v40, v40, v115
  v_mul_f32 v32, s56, v32
  v_mul_f32 v36, s56, v36
  v_mul_f32 v40, s56, v40
  v_exp_f32 v32, v32
  v_exp_f32 v36, v36
  v_exp_f32 v40, v40
  v_mul_f32 v115, v32, v33
  v_fmac_f32 v115, v36, v37
  v_fmac_f32 v115, v40, v41
  s_nop 1
  v_add_f32_dpp v115, v115, v115 row_ror:8 row_mask:0xf bank_mask:0xf
  v_mov_b32 v116, v115
  s_nop 1
  v_permlane16_swap_b32 v115, v116
  v_add_f32 v115, v115, v116
  v_mov_b32 v116, v115
  s_nop 1
  v_permlane32_swap_b32 v115, v116
  v_add_f32 v115, v115, v116
  v_rcp_f32 v115, v115
  s_nop 0
  v_mul_f32 v32, v32, v115
  v_mul_f32 v36, v36, v115
  v_mul_f32 v40, v40, v115
  s_mov_b32 s62, 0
  s_mov_b64 exec, s[60:61]
  s_branch L_h1_pi_25
L_h1_21:
  s_mov_b64 exec, s[60:61]
  buffer_load_dwordx4 v[88:91], v112, s[32:35], 0 offen sc1
  buffer_load_dwordx4 v[92:95], v112, s[32:35], s58 offen sc1
  s_mov_b64 exec, s[44:45]
  buffer_load_dwordx4 v[96:99], v112, s[32:35], s59 offen sc1
  s_mov_b64 exec, s[60:61]
L_h1_pi_25:
  s_waitcnt vmcnt(2)
  v_xor_b32 v44, s48, v88
  v_xor_b32 v45, s49, v89
  v_xor_b32 v46, s50, v90
  v_xor_b32 v47, s51, v91
  v_or_b32 v115, v44, v45
  v_or3_b32 v115, v46, v47, v115
  v_pk_mul_f32 v[44:45], v[44:45], v[32:33] op_sel:[0,0] op_sel_hi:[1,0]
  v_pk_mul_f32 v[46:47], v[46:47], v[32:33] op_sel:[0,0] op_sel_hi:[1,0]
  s_waitcnt vmcnt(1)
  v_xor_b32 v48, s48, v92
  v_xor_b32 v49, s49, v93
  v_xor_b32 v50, s50, v94
  v_xor_b32 v51, s51, v95
  v_or3_b32 v115, v48, v49, v115
  v_or3_b32 v115, v50, v51, v115
  v_pk_fma_f32 v[44:45], v[48:49], v[36:37], v[44:45] op_sel:[0,0,0] op_sel_hi:[1,0,1]
  v_pk_fma_f32 v[46:47], v[50:51], v[36:37], v[46:47] op_sel:[0,0,0] op_sel_hi:[1,0,1]
  s_waitcnt vmcnt(0)
  v_xor_b32 v52, s48, v96
  v_xor_b32 v53, s49, v97
  v_xor_b32 v54, s50, v98
  v_xor_b32 v55, s51, v99
  v_or3_b32 v115, v52, v53, v115
  v_or3_b32 v115, v54, v55, v115
  v_cmp_ne_u32_sdwa vcc, v115, 0 src0_sel:BYTE_0 src1_sel:DWORD
  v_pk_fma_f32 v[44:45], v[52:53], v[40:41], v[44:45] op_sel:[0,0,0] op_sel_hi:[1,0,1]
  v_pk_fma_f32 v[46:47], v[54:55], v[40:41], v[46:47] op_sel:[0,0,0] op_sel_hi:[1,0,1]
  s_cbranch_vccz L_h1_a_22
  s_add_u32 s62, s62, 1
  s_cmp_lt_u32 s62, 512
  s_cbranch_scc1 L_h1_nf_26
  s_mov_b64 exec, -1
  v_xor_b32 v112, s63, v112
L_h1_nf_26:
  s_cmp_lt_u32 s62, 2097152
  s_cbranch_scc1 L_h1_21
L_h1_a_22:
  s_mov_b64 exec, -1
L_h1_d_24:
  v_permlane32_swap_b32 v44, v46
  v_permlane32_swap_b32 v45, v47
  v_add_f32 v44, v44, v46
  v_add_f32 v45, v45, v47
  s_nop 1
  v_permlane16_swap_b32 v44, v45
  v_add_f32 v44, v44, v45
  s_nop 1
  v_add_f32_dpp v44, v44, v44 row_ror:8 row_mask:0xf bank_mask:0xf
  v_cvt_pk_bf16_f32 v44, v44, v44
  s_mov_b64 exec, s[46:47]
  ds_write_b32 v114, v44 offset:512
  s_mov_b64 exec, -1
  ds_write_b32 v7, v63 offset:8
  v_xor_b32 v34, s43, v34
  v_xor_b32 v38, s43, v38
  v_xor_b32 v42, s43, v42
  v_or3_b32 v116, v34, v38, v42
  v_cmp_ne_u32 vcc, 0, v116
  s_and_b64 vcc, vcc, s[60:61]
  s_cselect_b32 s55, 2, 1
  v_mov_b32 v116, s55
  ds_write_b32 v7, v116 offset:12
  s_endpgm
L_attw_b2:
  s_mov_b32 s61, 0
  s_mov_b32 s42, -1
  s_mov_b32 s43, 0
  s_mov_b32 s62, 0
L_w_w3_27:
  ds_read_b32 v62, v7 offset:8
  ds_read_b128 v[112:115], v4 offset:512
  ds_read_b64 v[116:117], v4 offset:528
  s_add_u32 s62, s62, 1
  s_waitcnt lgkmcnt(0)
  v_readfirstlane_b32 s55, v62
  s_cmp_lg_u32 s55, 0
  s_cbranch_scc1 L_w_w3_ok_28
  s_cmp_lg_u32 s62, 1024
  s_cbranch_scc1 L_w_w3_at_29
  s_mov_b64 exec, s[44:45]
  buffer_store_dwordx4 v[120:123], v61, s[32:35], s63 offen sc1
  s_mov_b64 exec, -1
L_w_w3_at_29:
  s_cmp_lt_u32 s62, 8388608
  s_cbranch_scc1 L_w_w3_27
L_w_w3_ok_28:
  s_cmp_lt_u32 s57, 2
  s_cbranch_scc1 L_attw_vd
  v_and_b32 v64, v56, v112
  v_and_b32 v65, v57, v112
  v_and_b32 v66, v58, v112
  v_and_b32 v67, v59, v112
  v_and_b32 v68, v56, v113
  v_and_b32 v69, v57, v113
  v_and_b32 v70, v58, v113
  v_and_b32 v71, v59, v113
  s_waitcnt vmcnt(0)
  v_mfma_f32_16x16x32_bf16 v[124:127], v[64:67], v[8:11], 0
  v_mfma_f32_16x16x32_bf16 v[88:91], v[64:67], v[32:35], 0
  v_and_b32 v72, v56, v114
  v_and_b32 v73, v57, v114
  v_and_b32 v74, v58, v114
  v_and_b32 v75, v59, v114
  v_mfma_f32_16x16x32_bf16 v[124:127], v[68:71], v[12:15], v[124:127]
  v_mfma_f32_16x16x32_bf16 v[88:91], v[68:71], v[36:39], v[88:91]
  v_and_b32 v76, v56, v115
  v_and_b32 v77, v57, v115
  v_and_b32 v78, v58, v115
  v_and_b32 v79, v59, v115
  v_mfma_f32_16x16x32_bf16 v[124:127], v[72:75], v[16:19], v[124:127]
  v_mfma_f32_16x16x32_bf16 v[88:91], v[72:75], v[40:43], v[88:91]
  v_and_b32 v80, v56, v116
  v_and_b32 v81, v57, v116
  v_and_b32 v82, v58, v116
  v_and_b32 v83, v59, v116
  v_mfma_f32_16x16x32_bf16 v[124:127], v[76:79], v[20:23], v[124:127]
  v_mfma_f32_16x16x32_bf16 v[88:91], v[76:79], v[44:47], v[88:91]
  v_and_b32 v84, v56, v117
  v_and_b32 v85, v57, v117
  v_and_b32 v86, v58, v117
  v_and_b32 v87, v59, v117
  v_mfma_f32_16x16x32_bf16 v[124:127], v[80:83], v[24:27], v[124:127]
  v_mfma_f32_16x16x32_bf16 v[88:91], v[80:83], v[48:51], v[88:91]
  v_mfma_f32_16x16x32_bf16 v[124:127], v[84:87], v[28:31], v[124:127]
  v_mfma_f32_16x16x32_bf16 v[88:91], v[84:87], v[52:55], v[88:91]
  s_nop 6
  v_and_or_b32 v124, v124, v5, s48
  v_and_or_b32 v125, v125, v5, s49
  v_and_or_b32 v126, v126, v5, s50
  v_and_or_b32 v127, v127, v5, s51
  s_mov_b64 exec, s[42:43]
  buffer_store_dwordx4 v[124:127], v3, s[32:35], 0 offen
  v_and_or_b32 v88, v88, v5, s48
  v_and_or_b32 v89, v89, v5, s49
  v_and_or_b32 v90, v90, v5, s50
  v_and_or_b32 v91, v91, v5, s51
  s_mov_b64 exec, s[60:61]
  buffer_store_dwordx4 v[88:91], v3, s[32:35], 0 offen offset:512
  s_mov_b64 exec, 1
  ds_add_u32 v7, v63 offset:28
  s_mov_b64 exec, -1
L_attw_vd:
  s_mov_b32 s62, 0
L_w_lz_30:
  ds_read_b32 v62, v7 offset:12
  s_add_u32 s62, s62, 1
  s_waitcnt lgkmcnt(0)
  v_readfirstlane_b32 s55, v62
  s_cmp_lg_u32 s55, 0
  s_cbranch_scc1 L_w_lz_ok_31
  s_sleep 1
  s_cmp_lt_u32 s62, 2097152
  s_cbranch_scc1 L_w_lz_30
L_w_lz_ok_31:
  s_cmp_eq_u32 s55, 1
  s_cbranch_scc1 L_done
  s_mov_b64 exec, s[44:45]
  buffer_store_dwordx4 v[120:123], v61, s[32:35], s63 offen sc1
  s_cmp_lt_u32 s57, 2
  s_cbranch_scc1 L_done
  s_mov_b64 exec, s[42:43]
  buffer_store_dwordx4 v[124:127], v3, s[32:35], s63 offen sc1
  s_mov_b64 exec, s[60:61]
  buffer_store_dwordx4 v[88:91], v3, s[32:35], s63 offen offset:512 sc1
  s_endpgm
L_svc_down:
  s_lshl_b32 s58, s53, 3
  s_mul_i32 s55, s53, 6
  s_add_u32 s55, s55, 8
  s_cmp_lt_u32 s53, 4
  s_cselect_b32 s58, s58, s55
  s_cselect_b32 s55, 8, 6
  s_add_u32 s58, s58, s54
  s_cmp_lt_u32 s54, s55
  s_cselect_b32 s58, s58, 56
  s_cmp_ge_u32 s58, 56
  s_cbranch_scc1 L_exit
  s_sub_u32 s57, s3, 8
  v_mul_u32_u24 v3, 896, v2
  v_lshl_add_u32 v3, v1, 4, v3
  s_lshl_b32 s55, s57, 8
  v_add_u32 v3, s55, v3
  s_cmp_lg_u32 s57, 3
  s_cbranch_scc1 L_dn_full
  v_cmp_lt_u32 vcc, 7, v1
  s_nop 1
  v_cndmask_b32 v4, 0, 1, vcc
  v_lshl_add_u32 v3, v4, 30, v3
L_dn_full:
  s_waitcnt lgkmcnt(0)
  s_mov_b32 s36, s20
  s_mov_b32 s37, s21
  s_mov_b32 s38, 1605632
  s_mov_b32 s39, 0x20000
  s_load_dword s52, s[30:31], 0
  s_mov_b32 s32, s30
  s_mov_b32 s33, s31
  s_mov_b32 s34, 4194304
  s_mov_b32 s35, 0x20000
  s_mov_b32 s63, 2097152
  s_waitcnt lgkmcnt(0)
  s_add_u32 s52, s52, 1
  s_mul_i32 s55, s52, 0x9E3779B1
  s_and_b32 s48, s52, 0x7f
  s_bfe_u32 s49, s55, 458760
  s_bfe_u32 s50, s55, 458768
  s_bfe_u32 s51, s55, 458776
  s_bitset1_b32 s48, 7
  s_bitset1_b32 s49, 7
  s_bitset1_b32 s50, 7
  s_bitset1_b32 s51, 7
  s_mul_i32 s56, s58, 28672
  v_lshlrev_b32 v4, 4, v1
  v_lshl_add_u32 v4, v2, 8, v4
  s_lshl_b32 s55, s3, 8
  v_lshl_add_u32 v6, v2, 4, s55
  v_and_b32 v5, 7, v0
  v_lshl_add_u32 v5, v5, 1, v6
  v_lshrrev_b32 v7, 3, v1
  v_lshl_add_u32 v5, v7, 6, v5
  s_mul_i32 s55, s58, 1792
  s_add_u32 s55, s55, 196608
  s_lshl_b32 s59, s57, 9
  s_add_u32 s55, s55, s59
  v_lshlrev_b32 v7, 5, v1
  v_lshl_add_u32 v7, v2, 4, v7
  v_add_u32 v7, s55, v7
  v_mov_b32 v76, 0xffffff00
  v_mov_b32 v77, 0xc0135761
  s_mov_b32 s60, -1
  s_cmp_eq_u32 s57, 3
  s_cselect_b32 s60, 0x00ff00ff, s60
  s_mov_b32 s61, 0
  s_barrier
  s_barrier
  s_barrier
  buffer_load_dwordx4 v[8:11], v3, s[36:39], s56 offen offset:0 nt
  buffer_load_dwordx4 v[12:15], v3, s[36:39], s56 offen offset:3584 nt
  s_add_u32 s56, s56, 7168
  buffer_load_dwordx4 v[16:19], v3, s[36:39], s56 offen offset:0 nt
  buffer_load_dwordx4 v[20:23], v3, s[36:39], s56 offen offset:3584 nt
  s_add_u32 s56, s56, 7168
  buffer_load_dwordx4 v[24:27], v3, s[36:39], s56 offen offset:0 nt
  buffer_load_dwordx4 v[28:31], v3, s[36:39], s56 offen offset:3584 nt
  s_add_u32 s56, s56, 7168
  buffer_load_dwordx4 v[32:35], v3, s[36:39], s56 offen offset:0 nt
  buffer_load_dwordx4 v[36:39], v3, s[36:39], s56 offen offset:3584 nt
  s_setprio 3
  s_mov_b32 s56, 0xbdd2d3e8
  v_mov_b32 v78, 0
  s_mov_b32 s46, 0x05040100
  s_mov_b32 s47, 0x07060302
  s_mov_b32 s42, 0xffff0000
  s_mov_b32 s43, 0
  s_waitcnt vmcnt(0)
  v_perm_b32 v44, v12, v8, s46
  v_perm_b32 v48, v12, v8, s47
  v_perm_b32 v45, v20, v16, s46
  v_perm_b32 v49, v20, v16, s47
  v_perm_b32 v46, v28, v24, s46
  v_perm_b32 v50, v28, v24, s47
  v_perm_b32 v47, v36, v32, s46
  v_perm_b32 v51, v36, v32, s47
  v_perm_b32 v52, v13, v9, s46
  v_perm_b32 v56, v13, v9, s47
  v_perm_b32 v53, v21, v17, s46
  v_perm_b32 v57, v21, v17, s47
  v_perm_b32 v54, v29, v25, s46
  v_perm_b32 v58, v29, v25, s47
  v_perm_b32 v55, v37, v33, s46
  v_perm_b32 v59, v37, v33, s47
  v_perm_b32 v60, v14, v10, s46
  v_perm_b32 v64, v14, v10, s47
  v_perm_b32 v61, v22, v18, s46
  v_perm_b32 v65, v22, v18, s47
  v_perm_b32 v62, v30, v26, s46
  v_perm_b32 v66, v30, v26, s47
  v_perm_b32 v63, v38, v34, s46
  v_perm_b32 v67, v38, v34, s47
  v_perm_b32 v68, v15, v11, s46
  v_perm_b32 v72, v15, v11, s47
  v_perm_b32 v69, v23, v19, s46
  v_perm_b32 v73, v23, v19, s47
  v_perm_b32 v70, v31, v27, s46
  v_perm_b32 v74, v31, v27, s47
  v_perm_b32 v71, v39, v35, s46
  v_perm_b32 v75, v39, v35, s47
  s_barrier
  ds_read_b128 v[80:83], v4 offset:12288
  ds_read_b128 v[84:87], v4 offset:13312
  ds_read_b128 v[88:91], v4 offset:14336
  ds_read_b128 v[92:95], v4 offset:15360
  ds_read_b128 v[96:99], v4 offset:16384
  ds_read_b128 v[100:103], v4 offset:17408
  ds_read_b128 v[104:107], v4 offset:18432
  ds_read_b128 v[108:111], v4 offset:19456
  ds_read_b32 v79, v78 offset:8256
  s_waitcnt lgkmcnt(0)
  v_pk_add_f32 v[80:81], v[80:81], v[84:85]
  v_pk_add_f32 v[82:83], v[82:83], v[86:87]
  v_pk_add_f32 v[88:89], v[88:89], v[92:93]
  v_pk_add_f32 v[90:91], v[90:91], v[94:95]
  v_pk_add_f32 v[80:81], v[80:81], v[88:89]
  v_pk_add_f32 v[82:83], v[82:83], v[90:91]
  v_pk_add_f32 v[96:97], v[96:97], v[100:101]
  v_pk_add_f32 v[98:99], v[98:99], v[102:103]
  v_pk_add_f32 v[104:105], v[104:105], v[108:109]
  v_pk_add_f32 v[106:107], v[106:107], v[110:111]
  v_pk_add_f32 v[96:97], v[96:97], v[104:105]
  v_pk_add_f32 v[98:99], v[98:99], v[106:107]
  v_permlane32_swap_b32 v80, v82
  v_permlane32_swap_b32 v81, v83
  v_permlane32_swap_b32 v96, v98
  v_permlane32_swap_b32 v97, v99
  v_add_f32 v80, v80, v82
  v_add_f32 v81, v81, v83
  v_add_f32 v96, v96, v98
  v_add_f32 v97, v97, v99
  v_permlane16_swap_b32 v80, v81
  s_nop 0
  v_permlane16_swap_b32 v96, v97
  v_add_f32 v80, v80, v81
  v_add_f32 v96, v96, v97
  v_mov_b32 v40, v80
  v_mov_b32 v41, v96
  s_barrier
  ds_read_b128 v[96:99], v78 offset:8192
  ds_read_b128 v[100:103], v78 offset:8208
  ds_read_b128 v[104:107], v78 offset:8224
  ds_read_b128 v[108:111], v78 offset:8240
  ds_read_b128 v[80:83], v4 offset:4096
  ds_read_b128 v[84:87], v4 offset:5120
  ds_read_b128 v[88:91], v4 offset:6144
  ds_read_b128 v[92:95], v4 offset:7168
  s_waitcnt lgkmcnt(6)
  v_pk_add_f32 v[96:97], v[96:97], v[98:99]
  v_pk_add_f32 v[100:101], v[100:101], v[102:103]
  s_waitcnt lgkmcnt(4)
  v_pk_add_f32 v[104:105], v[104:105], v[106:107]
  v_pk_add_f32 v[96:97], v[96:97], v[100:101]
  v_pk_add_f32 v[104:105], v[104:105], v[108:109]
  v_pk_add_f32 v[96:97], v[96:97], v[104:105]
  s_waitcnt lgkmcnt(2)
  v_pk_add_f32 v[80:81], v[80:81], v[84:85]
  v_mul_f32 v96, 0x3b124925, v96
  v_mul_f32 v97, 0x3b124925, v97
  v_pk_add_f32 v[82:83], v[82:83], v[86:87]
  v_fma_f32 v97, -v96, v96, v97
  v_add_f32 v96, v96, v79
  s_waitcnt lgkmcnt(0)
  v_pk_add_f32 v[88:89], v[88:89], v[92:93]
  v_max_f32 v97, 0, v97
  v_pk_add_f32 v[90:91], v[90:91], v[94:95]
  v_cvt_pk_bf16_f32 v97, v97, v96
  v_pk_add_f32 v[80:81], v[80:81], v[88:89]
  v_pk_add_f32 v[82:83], v[82:83], v[90:91]
  v_and_b32 v96, 0xffff0000, v97
  v_lshlrev_b32 v97, 16, v97
  v_permlane32_swap_b32 v80, v82
  v_add_f32 v97, 0x3727c5ac, v97
  v_permlane32_swap_b32 v81, v83
  v_cvt_pk_bf16_f32 v97, v97, v97
  v_add_f32 v80, v80, v82
  v_add_f32 v81, v81, v83
  v_lshlrev_b32 v97, 16, v97
  v_sqrt_f32 v97, v97
  v_permlane16_swap_b32 v80, v81
  v_cvt_pk_bf16_f32 v97, v97, v97
  v_sub_f32 v96, v96, v79
  v_lshlrev_b32 v97, 16, v97
  v_add_f32 v80, v80, v81
  v_rcp_f32 v97, v97
  v_fma_f32 v80, -v96, v40, v80
  v_fma_f32 v80, v80, v97, v41
  v_cvt_pk_bf16_f32 v80, v80, v80
  v_lshlrev_b32 v80, 16, v80
  v_mul_f32 v81, v80, v80
  s_nop 0
  v_mov_b32_dpp v83, v80 row_ror:8 row_mask:0xf bank_mask:0xf
  v_fma_f32 v82, s56, v81, v77
  v_mul_f32 v82, v82, v80
  v_exp_f32 v82, v82
  s_nop 0
  v_add_f32 v82, 1.0, v82
  v_rcp_f32 v82, v82
  s_nop 0
  v_mul_f32 v80, v80, v82
  v_cvt_pk_bf16_f32 v80, v80, v80
  v_lshlrev_b32 v80, 16, v80
  v_mul_f32 v84, v80, v83
  s_nop 1
  v_mov_b32_dpp v85, v84 quad_perm:[1,0,3,2] row_mask:0xf bank_mask:0xf
  v_cvt_pk_bf16_f32 v84, v84, v85
  s_nop 1
  v_mov_b32_dpp v80, v84 row_newbcast:0 row_mask:0xf bank_mask:0xf
  v_mov_b32_dpp v81, v84 row_newbcast:2 row_mask:0xf bank_mask:0xf
  v_mov_b32_dpp v82, v84 row_newbcast:4 row_mask:0xf bank_mask:0xf
  v_mov_b32_dpp v83, v84 row_newbcast:6 row_mask:0xf bank_mask:0xf
  s_nop 1
  v_mfma_f32_16x16x32_bf16 v[8:11], v[80:83], v[44:47], 0
  v_mfma_f32_16x16x32_bf16 v[24:27], v[80:83], v[60:63], 0
  v_mfma_f32_16x16x32_bf16 v[12:15], v[80:83], v[48:51], 0
  v_mfma_f32_16x16x32_bf16 v[28:31], v[80:83], v[64:67], 0
  v_mfma_f32_16x16x32_bf16 v[16:19], v[80:83], v[52:55], 0
  v_mfma_f32_16x16x32_bf16 v[32:35], v[80:83], v[68:71], 0
  v_mfma_f32_16x16x32_bf16 v[20:23], v[80:83], v[56:59], 0
  v_mfma_f32_16x16x32_bf16 v[36:39], v[80:83], v[72:75], 0
  s_nop 1
  v_cndmask_b32 v120, v8, v24, s[42:43]
  s_nop 0
  v_cndmask_b32 v121, v12, v28, s[42:43]
  s_nop 0
  v_cndmask_b32 v122, v16, v32, s[42:43]
  s_nop 0
  v_cndmask_b32 v123, v20, v36, s[42:43]
  v_and_or_b32 v124, v120, v76, s48
  v_and_or_b32 v125, v121, v76, s49
  v_and_or_b32 v126, v122, v76, s50
  v_and_or_b32 v127, v123, v76, s51
  s_mov_b64 exec, s[60:61]
  buffer_store_dwordx4 v[124:127], v7, s[32:35], 0 offen sc1
  s_mov_b64 exec, -1
  s_endpgm
L_z:
  s_cmp_ge_u32 s57, 14
  s_cbranch_scc1 L_exit
  s_barrier
  v_and_b32 v1, 7, v0
  v_lshrrev_b32 v3, 3, v0
  s_lshl_b32 s55, s57, 7
  v_lshl_add_u32 v4, v1, 4, s55
  v_mul_u32_u24 v5, 10752, v2
  v_add_u32 v5, v5, v4
  v_add_u32 v5, 7680, v5
  v_add_u32 v8, 5376, v5
  v_mul_u32_u24 v6, 1792, v3
  v_add_u32 v6, v6, v4
  s_mul_i32 s56, s53, 16384
  s_add_u32 s56, s56, 393216
  v_add_u32 v9, s56, v6
  v_add_u32 v6, 196608, v6
  v_lshl_add_u32 v7, v2, 2, v4
  v_lshrrev_b32 v7, 1, v7
  s_waitcnt lgkmcnt(0)
  global_load_ushort v10, v7, s[4:5]
  s_load_dword s52, s[30:31], 0
  s_mov_b32 s32, s30
  s_mov_b32 s33, s31
  s_mov_b32 s34, 4194304
  s_mov_b32 s35, 0x20000
  s_mov_b32 s63, 2097152
  s_waitcnt lgkmcnt(0)
  s_add_u32 s52, s52, 1
  s_mul_i32 s55, s52, 0x9E3779B1
  s_and_b32 s48, s52, 0x7f
  s_bfe_u32 s49, s55, 458760
  s_bfe_u32 s50, s55, 458768
  s_bfe_u32 s51, s55, 458776
  s_bitset1_b32 s48, 7
  s_bitset1_b32 s49, 7
  s_bitset1_b32 s50, 7
  s_bitset1_b32 s51, 7
  s_and_b32 s6, s48, 15
  s_and_b32 s7, s49, 15
  s_and_b32 s8, s50, 15
  s_and_b32 s9, s51, 15
  s_mov_b32 s36, 14336
  s_mov_b32 s37, 28672
  s_mov_b32 s38, 43008
  s_mov_b32 s39, 57344
  s_mov_b32 s40, 71680
  s_mov_b32 s41, 86016
  s_mov_b32 s62, 0
L_g_47:
  buffer_load_dwordx4 v[16:19], v5, s[32:35], 0 offen sc1
  buffer_load_dwordx4 v[20:23], v8, s[32:35], 0 offen sc1
  s_waitcnt vmcnt(1)
  v_xor_b32 v24, s6, v16
  v_xor_b32 v25, s7, v17
  v_xor_b32 v26, s8, v18
  v_xor_b32 v27, s9, v19
  v_or_b32 v11, v24, v25
  v_or3_b32 v11, v26, v27, v11
  s_waitcnt vmcnt(0)
  v_xor_b32 v28, s6, v20
  v_xor_b32 v29, s7, v21
  v_xor_b32 v30, s8, v22
  v_xor_b32 v31, s9, v23
  v_or3_b32 v11, v28, v29, v11
  v_or3_b32 v11, v30, v31, v11
  v_and_b32 v11, 15, v11
  v_cmp_ne_u32 vcc, 0, v11
  s_cbranch_vccz L_g_a_48
  s_add_u32 s62, s62, 1
  s_sleep 1
  s_cmp_lt_u32 s62, 2097152
  s_cbranch_scc1 L_g_47
L_g_a_48:
L_g_d_50:
  buffer_load_dword v32, v6, s[32:35], 0 offen sc1
  buffer_load_dword v33, v6, s[32:35], s36 offen sc1
  buffer_load_dword v34, v6, s[32:35], s37 offen sc1
  buffer_load_dword v35, v6, s[32:35], s38 offen sc1
  buffer_load_dword v36, v6, s[32:35], s39 offen sc1
  buffer_load_dword v37, v6, s[32:35], s40 offen sc1
  buffer_load_dword v38, v6, s[32:35], s41 offen sc1
  v_lshl_add_u32 v40, v0, 7, s56
  buffer_load_dword v41, v40, s[32:35], 0 offen sc1
  v_add_u32 v40, 8192, v40
  buffer_load_dword v41, v40, s[32:35], 0 offen sc1
  v_permlane32_swap_b32 v24, v26
  v_permlane32_swap_b32 v25, v27
  v_permlane32_swap_b32 v28, v30
  v_permlane32_swap_b32 v29, v31
  v_add_f32 v24, v24, v26
  v_add_f32 v25, v25, v27
  v_add_f32 v28, v28, v30
  v_add_f32 v29, v29, v31
  v_permlane16_swap_b32 v24, v25
  s_nop 0
  v_permlane16_swap_b32 v28, v29
  v_add_f32 v24, v24, v25
  v_add_f32 v28, v28, v29
  v_cvt_pk_bf16_f32 v12, v24, v24
  v_lshlrev_b32 v12, 16, v12
  v_cvt_pk_bf16_f32 v13, v28, v28
  v_lshlrev_b32 v13, 16, v13
  v_lshlrev_b32 v10, 16, v10
  s_setprio 3
  s_mov_b32 s62, 0
L_zx_51:
  buffer_load_dwordx4 v[16:19], v9, s[32:35], 0 offen sc1
  s_waitcnt vmcnt(0)
  v_xor_b32 v24, s48, v16
  v_xor_b32 v25, s49, v17
  v_xor_b32 v26, s50, v18
  v_xor_b32 v27, s51, v19
  v_or_b32 v11, v24, v25
  v_or3_b32 v11, v26, v27, v11
  v_cmp_ne_u32_sdwa vcc, v11, 0 src0_sel:BYTE_0 src1_sel:DWORD
  s_cbranch_vccz L_zx_a_52
  s_add_u32 s62, s62, 1
  s_sleep 1
  s_cmp_lt_u32 s62, 2097152
  s_cbranch_scc1 L_zx_51
L_zx_a_52:
L_zx_d_54:
  v_permlane32_swap_b32 v24, v26
  v_permlane32_swap_b32 v25, v27
  v_add_f32 v24, v24, v26
  v_add_f32 v25, v25, v27
  s_nop 1
  v_permlane16_swap_b32 v24, v25
  v_add_f32 v24, v24, v25
  s_nop 1
  v_add_f32_dpp v24, v24, v24 row_ror:8 row_mask:0xf bank_mask:0xf
  v_cvt_pk_bf16_f32 v24, v24, v24
  v_lshlrev_b32 v24, 16, v24
  v_mul_f32 v24, v12, v24
  v_cvt_pk_bf16_f32 v24, v24, v24
  v_lshlrev_b32 v24, 16, v24
  v_add_f32 v24, v10, v24
  v_cvt_pk_bf16_f32 v10, v24, v24
  v_lshlrev_b32 v10, 16, v10
  s_mov_b32 s60, 0x00ff00ff
  s_mov_b32 s61, 0x00ff00ff
  s_mov_b32 s62, 0
L_z_55:
  buffer_load_dwordx4 v[16:19], v6, s[32:35], 0 offen sc1
  buffer_load_dwordx4 v[20:23], v6, s[32:35], s36 offen sc1
  buffer_load_dwordx4 v[24:27], v6, s[32:35], s37 offen sc1
  buffer_load_dwordx4 v[28:31], v6, s[32:35], s38 offen sc1
  buffer_load_dwordx4 v[32:35], v6, s[32:35], s39 offen sc1
  buffer_load_dwordx4 v[36:39], v6, s[32:35], s40 offen sc1
  buffer_load_dwordx4 v[40:43], v6, s[32:35], s41 offen sc1
  s_waitcnt vmcnt(6)
  v_xor_b32 v72, s48, v16
  v_xor_b32 v73, s49, v17
  v_xor_b32 v74, s50, v18
  v_xor_b32 v75, s51, v19
  v_or_b32 v11, v72, v73
  v_or3_b32 v11, v74, v75, v11
  s_waitcnt vmcnt(5)
  v_xor_b32 v76, s48, v20
  v_xor_b32 v77, s49, v21
  v_xor_b32 v78, s50, v22
  v_xor_b32 v79, s51, v23
  v_or3_b32 v11, v76, v77, v11
  v_or3_b32 v11, v78, v79, v11
  v_pk_add_f32 v[72:73], v[72:73], v[76:77]
  v_pk_add_f32 v[74:75], v[74:75], v[78:79]
  s_waitcnt vmcnt(4)
  v_xor_b32 v80, s48, v24
  v_xor_b32 v81, s49, v25
  v_xor_b32 v82, s50, v26
  v_xor_b32 v83, s51, v27
  v_or3_b32 v11, v80, v81, v11
  v_or3_b32 v11, v82, v83, v11
  v_pk_add_f32 v[72:73], v[72:73], v[80:81]
  v_pk_add_f32 v[74:75], v[74:75], v[82:83]
  s_waitcnt vmcnt(3)
  v_xor_b32 v84, s48, v28
  v_xor_b32 v85, s49, v29
  v_xor_b32 v86, s50, v30
  v_xor_b32 v87, s51, v31
  v_or3_b32 v11, v84, v85, v11
  v_or3_b32 v11, v86, v87, v11
  v_pk_add_f32 v[72:73], v[72:73], v[84:85]
  v_pk_add_f32 v[74:75], v[74:75], v[86:87]
  s_waitcnt vmcnt(2)
  v_xor_b32 v88, s48, v32
  v_xor_b32 v89, s49, v33
  v_xor_b32 v90, s50, v34
  v_xor_b32 v91, s51, v35
  v_or3_b32 v11, v88, v89, v11
  v_or3_b32 v11, v90, v91, v11
  v_pk_add_f32 v[72:73], v[72:73], v[88:89]
  v_pk_add_f32 v[74:75], v[74:75], v[90:91]
  s_waitcnt vmcnt(1)
  v_xor_b32 v92, s48, v36
  v_xor_b32 v93, s49, v37
  v_xor_b32 v94, s50, v38
  v_xor_b32 v95, s51, v39
  v_or3_b32 v11, v92, v93, v11
  v_or3_b32 v11, v94, v95, v11
  v_pk_add_f32 v[72:73], v[72:73], v[92:93]
  v_pk_add_f32 v[74:75], v[74:75], v[94:95]
  s_waitcnt vmcnt(0)
  v_xor_b32 v96, s48, v40
  v_xor_b32 v97, s49, v41
  v_xor_b32 v98, s50, v42
  v_xor_b32 v99, s51, v43
  v_or3_b32 v11, v96, v97, v11
  v_or3_b32 v11, v98, v99, v11
  v_cmp_ne_u32_sdwa vcc, v11, 0 src0_sel:BYTE_0 src1_sel:DWORD
  v_pk_add_f32 v[72:73], v[72:73], v[96:97]
  v_pk_add_f32 v[74:75], v[74:75], v[98:99]
  s_cbranch_vccz L_z_a_56
  s_add_u32 s62, s62, 1
  s_sleep 1
  s_cmp_lt_u32 s62, 2097152
  s_cbranch_scc1 L_z_55
L_z_a_56:
L_z_d_58:
  s_nop 0
  v_permlane32_swap_b32 v72, v74
  v_permlane32_swap_b32 v73, v75
  v_add_f32 v72, v72, v74
  v_add_f32 v73, v73, v75
  s_nop 1
  v_permlane16_swap_b32 v72, v73
  v_add_f32 v72, v72, v73
  s_nop 1
  v_add_f32_dpp v72, v72, v72 row_ror:8 row_mask:0xf bank_mask:0xf
  v_cvt_pk_bf16_f32 v72, v72, v72
  v_lshlrev_b32 v72, 16, v72
  v_mul_f32 v72, v13, v72
  v_cvt_pk_bf16_f32 v72, v72, v72
  v_lshlrev_b32 v72, 16, v72
  v_add_f32 v72, v10, v72
  v_cvt_pk_bf16_f32 v72, v72, v72
  s_mov_b64 exec, s[60:61]
  global_store_short v7, v72, s[26:27]
  s_mov_b64 exec, 1
  s_cmp_lg_u32 s57, 0
  s_cbranch_scc1 L_z_noe
  v_mov_b32 v13, s52
  v_mov_b32 v14, 0
  buffer_store_dword v13, v14, s[32:35], 0 offen
L_z_noe:
  s_mov_b64 exec, -1
  s_endpgm
L_last:
.fill ((1024 - ((L_last-adaLN_cond__sliding_block_cached__geglu_ffn__decode_kernel) & 1023)) & 1023)/4, 4, 0xBF800000
L_codeend:
.section .rodata,"a"
.p2align 6
.amdhsa_kernel adaLN_cond__sliding_block_cached__geglu_ffn__decode_kernel
  .amdhsa_next_free_vgpr 128
  .amdhsa_next_free_sgpr 64
  .amdhsa_accum_offset 128
  .amdhsa_group_segment_fixed_size 0
  .amdhsa_kernarg_size 112
  .amdhsa_user_sgpr_count 2
  .amdhsa_user_sgpr_kernarg_segment_ptr 1
  .amdhsa_system_sgpr_workgroup_id_x 1
.end_amdhsa_kernel
```
